```python
import torch

def _softmax(x, axis=-1):
    return torch.softmax(x, dim=axis)
def _gelu(x):
    return torch.nn.functional.gelu(x, approximate="tanh")
def _silu(x):
    return torch.nn.functional.silu(x)
def _sigmoid(x):
    return torch.sigmoid(x)
def _layernorm(x, axis=-1, eps=1e-5):
    m = x.mean(dim=axis, keepdim=True)
    v = x.var(dim=axis, keepdim=True, unbiased=False)
    return (x - m) / torch.sqrt(v + eps)
def _scatter_add(tgt, idx, src, axis=0):
    return tgt.clone().index_add_(axis, idx, src)
def _segment_sum(src, seg, n):
    out = torch.zeros((n,) + src.shape[1:], dtype=src.dtype)
    return out.index_add_(0, seg, src)
def _pad(x, pw):
    flat = tuple(v for pair in reversed(pw) for v in pair)
    return torch.nn.functional.pad(x, flat)

kernel_name = 'standalone__self_sup_conv_stem_wavlm__speech'

def setup_inputs():

    _w = (lambda a: (lambda t: t.to(torch.bfloat16) if t.is_floating_point() else t)(torch.as_tensor(a)))
    B, T, D, K = 2, 16000, 256, 31
    scale = (K * D) ** -0.5
    return {
        "x": _w((lambda *s: torch.randn(*s, dtype=torch.bfloat16) * 0.05)(B, T, D)),
        "w": _w((lambda *s: torch.randn(*s, dtype=torch.bfloat16) * 0.05)(K, D, D) * scale),
        "gn_gamma": _w((lambda *s: torch.randn(*s, dtype=torch.bfloat16) * 0.05)(D) * 0.1 + 1.0),
        "gn_beta": _w((lambda *s: torch.randn(*s, dtype=torch.bfloat16) * 0.05)(D) * 0.1),
    }

def reference(x, w, gn_gamma, gn_beta):
    B, T, D = x.shape
    K = w.shape[0]
    s = 2
    L = (T - K) // s + 1
    h = torch.einsum('blc,cd->bld', x[:, 0:s * L:s, :], w[0])
    for i in range(1, K):
        h = h + torch.einsum('blc,cd->bld', x[:, i:i + s * L:s, :], w[i])
    mu = torch.einsum('bld->bd', h)[:, None, :] / L
    var = torch.einsum('bld->bd', (h - mu) ** 2)[:, None, :] / L
    h = (h - mu) / torch.sqrt(var + 1e-5)
    h = h * gn_gamma[None, None, :] + gn_beta[None, None, :]
    return _gelu(h)
```

```asm
; @launch grid=(256,1,1) block=(512,1,1) lds=163840
.amdgcn_target "amdgcn-amd-amdhsa--gfx950"
.text
.globl standalone__self_sup_conv_stem_wavlm__speech_kernel
.p2align 8
.type standalone__self_sup_conv_stem_wavlm__speech_kernel,@function
standalone__self_sup_conv_stem_wavlm__speech_kernel:
    s_cmp_ge_u32 s2, 256
    s_cbranch_scc1 L_end
    s_load_dwordx8 s[4:11], s[0:1], 0
    s_load_dwordx4 s[12:15], s[0:1], 32
    s_load_dwordx2 s[16:17], s[0:1], 48
    v_lshrrev_b32 v1, 6, v0
    v_mov_b32 v19, v0
    v_and_b32 v0, 63, v0
    s_and_b32 s51, s2, 7
    v_readfirstlane_b32 s44, v1
    s_lshr_b32 s52, s2, 3
    s_and_b32 s45, s52, 3
    s_lshr_b32 s52, s52, 2
    s_lshl_b32 s46, s51, 3
    s_add_u32 s46, s46, s52
    s_lshr_b32 s47, s46, 5
    s_lshr_b32 s75, s44, 2
    s_and_b32 s44, s44, 3
    s_and_b32 s48, s46, 31
    s_mul_i32 s49, s47, 8192000
    s_mul_i32 s51, s48, 261120
    s_add_u32 s49, s49, s51
    s_lshl_b32 s50, s45, 7
    v_lshrrev_b32 v20, 3, v0
    v_and_b32 v21, 7, v0
    v_lshlrev_b32 v22, 11, v20
    v_lshlrev_b32 v23, 4, v21
    v_add_u32 v2, v22, v23
    s_lshl_b32 s51, s44, 14
    s_add_u32 s58, s49, s51
    s_mul_i32 s56, s44, 1056
    v_lshrrev_b32 v22, 1, v0
    v_and_b32 v22, 3, v22
    v_and_b32 v23, 1, v0
    v_lshrrev_b32 v24, 1, v20
    v_and_b32 v24, 1, v24
    s_and_b32 s51, s44, 1
    s_lshl_b32 s51, s51, 1
    v_or_b32 v24, s51, v24
    v_xor_b32 v22, v22, v24
    v_lshlrev_b32 v24, 9, v20
    v_lshlrev_b32 v22, 5, v22
    v_lshlrev_b32 v23, 4, v23
    v_add3_u32 v24, v24, v22, v23
    s_lshl_b32 s51, s44, 12
    v_add_u32 v1, s51, v24
    s_lshl_b32 s55, s44, 10
    s_mov_b32 s57, s50
    s_mov_b32 s54, 0
    s_waitcnt lgkmcnt(0)
    s_mov_b32 s20, s4
    s_and_b32 s21, s5, 0xffff
    s_mov_b32 s22, 16384000
    s_mov_b32 s23, 0x00020000
    s_mov_b32 s24, s6
    s_and_b32 s25, s7, 0xffff
    s_mov_b32 s26, 4063232
    s_mov_b32 s27, 0x00020000
    s_cmp_eq_u32 s75, 0
    s_cbranch_scc1 L_consumer
    s_setprio 0
    s_add_u32 m0, s56, 0
    s_add_u32 s51, s58, 0
    buffer_load_dwordx4 v2, s[20:23], s51 offen lds
    s_add_u32 m0, s56, 4224
    s_add_u32 s51, s58, 65536
    buffer_load_dwordx4 v2, s[20:23], s51 offen lds
    s_add_u32 m0, s56, 8448
    s_add_u32 s51, s58, 131072
    buffer_load_dwordx4 v2, s[20:23], s51 offen lds
    s_add_u32 m0, s56, 12672
    s_add_u32 s51, s58, 196608
    buffer_load_dwordx4 v2, s[20:23], s51 offen lds
    s_mov_b32 m0, 16896
    s_add_u32 s51, s49, 262144
    s_mov_b32 exec_hi, 0xffffff
    buffer_load_dwordx4 v2, s[20:23], s51 offen lds
    s_mov_b32 exec_hi, -1
    s_add_u32 m0, s55, 35584
    s_add_u32 s51, s57, 0
    s_mov_b32 s52, 0
L_pw0:
    buffer_load_dwordx4 v1, s[24:27], s51 offen lds
    s_add_u32 m0, m0, 4096
    s_add_u32 s51, s51, 524288
    s_add_u32 s52, s52, 1
    s_cmp_lt_u32 s52, 8
    s_cbranch_scc1 L_pw0
    s_add_u32 m0, s55, 68352
    s_add_u32 s51, s57, 16384
    s_mov_b32 s52, 0
L_pw1:
    buffer_load_dwordx4 v1, s[24:27], s51 offen lds
    s_add_u32 m0, m0, 4096
    s_add_u32 s51, s51, 524288
    s_add_u32 s52, s52, 1
    s_cmp_lt_u32 s52, 8
    s_cbranch_scc1 L_pw1
    s_add_u32 m0, s55, 101120
    s_add_u32 s51, s57, 262144
    s_mov_b32 s52, 0
L_pw2:
    buffer_load_dwordx4 v1, s[24:27], s51 offen lds
    s_add_u32 m0, m0, 4096
    s_add_u32 s51, s51, 524288
    s_add_u32 s52, s52, 1
    s_cmp_lt_u32 s52, 8
    s_cbranch_scc1 L_pw2
    s_mov_b32 s28, s12
    s_and_b32 s29, s13, 0xffff
    s_mov_b32 s30, 8176640
    s_mov_b32 s31, 0x00020000
    s_mov_b32 s32, s16
    s_and_b32 s33, s17, 0xffff
    s_mov_b32 s34, 139264
    s_mov_b32 s35, 0x00020000
    s_add_u32 s36, s16, 1048576
    s_addc_u32 s37, s17, 0
    s_and_b32 s37, s37, 0xffff
    s_mov_b32 s38, 2097152
    s_mov_b32 s39, 0x00020000
    s_add_u32 s40, s16, 4194304
    s_addc_u32 s41, s17, 0
    s_and_b32 s41, s41, 0xffff
    s_mov_b32 s42, 9437184
    s_mov_b32 s43, 0x00020000
    v_lshlrev_b32 v3, 4, v0
    v_lshrrev_b32 v22, 2, v21
    v_mul_u32_u24 v22, 9216, v22
    v_lshlrev_b32 v23, 6, v20
    v_add_u32 v22, v22, v23
    v_and_b32 v23, 3, v21
    v_lshlrev_b32 v23, 4, v23
    v_add_u32 v5, v22, v23
    s_mul_i32 s67, s46, 147456
    s_lshl_b32 s51, s44, 10
    s_add_u32 s59, s67, s51
    s_lshl_b32 s69, s44, 2
    s_add_u32 s69, s69, s45
    s_and_b32 s51, s69, 1
    s_lshl_b32 s52, s51, 5
    v_xor_b32 v6, s52, v5
    s_lshl_b32 s52, s69, 14
    s_add_u32 s73, s49, s52
    s_lshl_b32 s52, s69, 9
    s_add_u32 s74, s67, s52
    s_lshr_b32 s69, s69, 1
    s_lshl_b32 s60, s51, 9
    s_add_u32 s60, s60, s49
    s_mul_i32 s61, s51, 73728
    s_add_u32 s61, s61, s67
    s_mov_b32 s66, s50
    s_mov_b32 s68, 0
    s_mul_i32 s71, s44, 1088
    v_mov_b32 v7, 0
    s_lshl_b32 s54, s46, 7
    s_add_u32 s54, s54, 131072
    s_waitcnt vmcnt(16)
    s_barrier
    s_add_u32 m0, s56, 17792
    s_add_u32 s51, s58, 1024
    buffer_load_dwordx4 v2, s[20:23], s51 offen lds
    s_add_u32 m0, s56, 22016
    s_add_u32 s51, s58, 66560
    buffer_load_dwordx4 v2, s[20:23], s51 offen lds
    s_add_u32 m0, s56, 26240
    s_add_u32 s51, s58, 132096
    buffer_load_dwordx4 v2, s[20:23], s51 offen lds
    s_add_u32 m0, s56, 30464
    s_add_u32 s51, s58, 197632
    buffer_load_dwordx4 v2, s[20:23], s51 offen lds
    s_mov_b32 m0, 34688
    s_add_u32 s51, s49, 263168
    s_mov_b32 exec_hi, 0xffffff
    buffer_load_dwordx4 v2, s[20:23], s51 offen lds
    s_mov_b32 exec_hi, -1
    s_add_u32 m0, s55, 133888
    s_add_u32 s51, s57, 278528
    buffer_load_dwordx4 v1, s[24:27], s51 offen lds
    s_add_u32 m0, s55, 137984
    s_add_u32 s51, s57, 802816
    buffer_load_dwordx4 v1, s[24:27], s51 offen lds
    s_add_u32 m0, s55, 142080
    s_add_u32 s51, s57, 1327104
    buffer_load_dwordx4 v1, s[24:27], s51 offen lds
    s_add_u32 m0, s55, 146176
    s_add_u32 s51, s57, 1851392
    buffer_load_dwordx4 v1, s[24:27], s51 offen lds
    s_add_u32 m0, s55, 150272
    s_add_u32 s51, s57, 2375680
    buffer_load_dwordx4 v1, s[24:27], s51 offen lds
    s_add_u32 m0, s55, 154368
    s_add_u32 s51, s57, 2899968
    buffer_load_dwordx4 v1, s[24:27], s51 offen lds
    s_add_u32 m0, s55, 158464
    s_add_u32 s51, s57, 3424256
    buffer_load_dwordx4 v1, s[24:27], s51 offen lds
    s_waitcnt vmcnt(20)
    s_barrier
    s_add_u32 m0, s55, 35584
    s_add_u32 s51, s57, 3948544
    buffer_load_dwordx4 v1, s[24:27], s51 offen lds
    s_add_u32 m0, s55, 39680
    s_add_u32 s51, s57, 131072
    buffer_load_dwordx4 v1, s[24:27], s51 offen lds
    s_add_u32 m0, s55, 43776
    s_add_u32 s51, s57, 655360
    buffer_load_dwordx4 v1, s[24:27], s51 offen lds
    s_add_u32 m0, s55, 47872
    s_add_u32 s51, s57, 1179648
    buffer_load_dwordx4 v1, s[24:27], s51 offen lds
    s_add_u32 m0, s55, 51968
    s_add_u32 s51, s57, 1703936
    buffer_load_dwordx4 v1, s[24:27], s51 offen lds
    s_add_u32 m0, s55, 56064
    s_add_u32 s51, s57, 2228224
    buffer_load_dwordx4 v1, s[24:27], s51 offen lds
    s_add_u32 m0, s55, 60160
    s_add_u32 s51, s57, 2752512
    buffer_load_dwordx4 v1, s[24:27], s51 offen lds
    s_add_u32 m0, s55, 64256
    s_add_u32 s51, s57, 3276800
    buffer_load_dwordx4 v1, s[24:27], s51 offen lds
    s_waitcnt vmcnt(15)
    s_barrier
    s_add_u32 s51, s73, 0
    buffer_load_dwordx4 v[120:123], v2, s[20:23], s51 offen offset:1024
    buffer_load_dwordx4 v[124:127], v2, s[20:23], s51 offen offset:2048
    s_add_u32 m0, s56, 0
    s_add_u32 s51, s58, 512
    buffer_load_dwordx4 v2, s[20:23], s51 offen lds
    s_add_u32 m0, s56, 4224
    s_add_u32 s51, s58, 66048
    buffer_load_dwordx4 v2, s[20:23], s51 offen lds
    s_add_u32 m0, s56, 8448
    s_add_u32 s51, s58, 131584
    buffer_load_dwordx4 v2, s[20:23], s51 offen lds
    s_add_u32 m0, s56, 12672
    s_add_u32 s51, s58, 197120
    buffer_load_dwordx4 v2, s[20:23], s51 offen lds
    s_mov_b32 m0, 16896
    s_add_u32 s51, s49, 262656
    s_mov_b32 exec_hi, 0xffffff
    buffer_load_dwordx4 v2, s[20:23], s51 offen lds
    s_mov_b32 exec_hi, -1
    s_add_u32 m0, s55, 68352
    s_add_u32 s51, s57, 3801088
    buffer_load_dwordx4 v1, s[24:27], s51 offen lds
    s_add_u32 m0, s55, 72448
    s_add_u32 s51, s57, 147456
    buffer_load_dwordx4 v1, s[24:27], s51 offen lds
    s_add_u32 m0, s55, 76544
    s_add_u32 s51, s57, 671744
    buffer_load_dwordx4 v1, s[24:27], s51 offen lds
    s_add_u32 m0, s55, 80640
    s_add_u32 s51, s57, 1196032
    buffer_load_dwordx4 v1, s[24:27], s51 offen lds
    s_add_u32 m0, s55, 84736
    s_add_u32 s51, s57, 1720320
    buffer_load_dwordx4 v1, s[24:27], s51 offen lds
    s_add_u32 m0, s55, 88832
    s_add_u32 s51, s57, 2244608
    buffer_load_dwordx4 v1, s[24:27], s51 offen lds
    s_add_u32 m0, s55, 92928
    s_add_u32 s51, s57, 2768896
    buffer_load_dwordx4 v1, s[24:27], s51 offen lds
    s_add_u32 m0, s55, 97024
    s_add_u32 s51, s57, 3293184
    buffer_load_dwordx4 v1, s[24:27], s51 offen lds
    s_waitcnt vmcnt(22)
    s_barrier
    s_add_u32 m0, s55, 101120
    s_add_u32 s51, s57, 3817472
    buffer_load_dwordx4 v1, s[24:27], s51 offen lds
    s_add_u32 m0, s55, 105216
    s_add_u32 s51, s57, 393216
    buffer_load_dwordx4 v1, s[24:27], s51 offen lds
    s_add_u32 m0, s55, 109312
    s_add_u32 s51, s57, 917504
    buffer_load_dwordx4 v1, s[24:27], s51 offen lds
    s_add_u32 m0, s55, 113408
    s_add_u32 s51, s57, 1441792
    buffer_load_dwordx4 v1, s[24:27], s51 offen lds
    s_add_u32 m0, s55, 117504
    s_add_u32 s51, s57, 1966080
    buffer_load_dwordx4 v1, s[24:27], s51 offen lds
    s_add_u32 m0, s55, 121600
    s_add_u32 s51, s57, 2490368
    buffer_load_dwordx4 v1, s[24:27], s51 offen lds
    s_add_u32 m0, s55, 125696
    s_add_u32 s51, s57, 3014656
    buffer_load_dwordx4 v1, s[24:27], s51 offen lds
    s_add_u32 m0, s55, 129792
    s_add_u32 s51, s57, 3538944
    buffer_load_dwordx4 v1, s[24:27], s51 offen lds
    s_waitcnt vmcnt(15)
    s_barrier
    s_add_u32 m0, s56, 17792
    s_add_u32 s51, s58, 1536
    buffer_load_dwordx4 v2, s[20:23], s51 offen lds
    s_add_u32 m0, s56, 22016
    s_add_u32 s51, s58, 67072
    buffer_load_dwordx4 v2, s[20:23], s51 offen lds
    s_add_u32 m0, s56, 26240
    s_add_u32 s51, s58, 132608
    buffer_load_dwordx4 v2, s[20:23], s51 offen lds
    s_add_u32 m0, s56, 30464
    s_add_u32 s51, s58, 198144
    buffer_load_dwordx4 v2, s[20:23], s51 offen lds
    s_mov_b32 m0, 34688
    s_add_u32 s51, s49, 263680
    s_mov_b32 exec_hi, 0xffffff
    buffer_load_dwordx4 v2, s[20:23], s51 offen lds
    s_mov_b32 exec_hi, -1
    s_add_u32 m0, s55, 133888
    s_add_u32 s51, s57, 409600
    buffer_load_dwordx4 v1, s[24:27], s51 offen lds
    s_add_u32 m0, s55, 137984
    s_add_u32 s51, s57, 933888
    buffer_load_dwordx4 v1, s[24:27], s51 offen lds
    s_add_u32 m0, s55, 142080
    s_add_u32 s51, s57, 1458176
    buffer_load_dwordx4 v1, s[24:27], s51 offen lds
    s_add_u32 m0, s55, 146176
    s_add_u32 s51, s57, 1982464
    buffer_load_dwordx4 v1, s[24:27], s51 offen lds
    s_add_u32 m0, s55, 150272
    s_add_u32 s51, s57, 2506752
    buffer_load_dwordx4 v1, s[24:27], s51 offen lds
    s_add_u32 m0, s55, 154368
    s_add_u32 s51, s57, 3031040
    buffer_load_dwordx4 v1, s[24:27], s51 offen lds
    s_add_u32 m0, s55, 158464
    s_add_u32 s51, s57, 3555328
    buffer_load_dwordx4 v1, s[24:27], s51 offen lds
    s_waitcnt vmcnt(63)
    v_lshlrev_b32 v144, 16, v120
    v_and_b32 v145, 0xffff0000, v120
    v_lshlrev_b32 v146, 16, v124
    v_and_b32 v147, 0xffff0000, v124
    v_lshlrev_b32 v148, 16, v121
    v_and_b32 v149, 0xffff0000, v121
    v_lshlrev_b32 v150, 16, v125
    v_and_b32 v151, 0xffff0000, v125
    v_lshlrev_b32 v152, 16, v122
    v_and_b32 v153, 0xffff0000, v122
    v_lshlrev_b32 v154, 16, v126
    v_and_b32 v155, 0xffff0000, v126
    v_lshlrev_b32 v156, 16, v123
    v_and_b32 v157, 0xffff0000, v123
    v_lshlrev_b32 v158, 16, v127
    v_and_b32 v159, 0xffff0000, v127
    v_pk_add_f32 v[144:145], v[144:145], v[146:147] neg_lo:[0,1] neg_hi:[0,1]
    v_pk_add_f32 v[148:149], v[148:149], v[150:151] neg_lo:[0,1] neg_hi:[0,1]
    v_pk_add_f32 v[152:153], v[152:153], v[154:155] neg_lo:[0,1] neg_hi:[0,1]
    v_pk_add_f32 v[156:157], v[156:157], v[158:159] neg_lo:[0,1] neg_hi:[0,1]
    v_cvt_pk_bf16_f32 v160, v144, v145
    v_cvt_pk_bf16_f32 v161, v148, v149
    v_cvt_pk_bf16_f32 v162, v152, v153
    v_cvt_pk_bf16_f32 v163, v156, v157
    s_add_u32 s51, s74, 0
    buffer_store_dwordx4 v[160:163], v6, s[40:43], s51 offen sc1
    s_waitcnt vmcnt(20)
    s_barrier
    s_add_u32 m0, s55, 35584
    s_add_u32 s51, s57, 32768
    buffer_load_dwordx4 v1, s[24:27], s51 offen lds
    s_add_u32 m0, s55, 39680
    s_add_u32 s51, s57, 557056
    buffer_load_dwordx4 v1, s[24:27], s51 offen lds
    s_add_u32 m0, s55, 43776
    s_add_u32 s51, s57, 1081344
    buffer_load_dwordx4 v1, s[24:27], s51 offen lds
    s_add_u32 m0, s55, 47872
    s_add_u32 s51, s57, 1605632
    buffer_load_dwordx4 v1, s[24:27], s51 offen lds
    s_add_u32 m0, s55, 51968
    s_add_u32 s51, s57, 2129920
    buffer_load_dwordx4 v1, s[24:27], s51 offen lds
    s_add_u32 m0, s55, 56064
    s_add_u32 s51, s57, 2654208
    buffer_load_dwordx4 v1, s[24:27], s51 offen lds
    s_add_u32 m0, s55, 60160
    s_add_u32 s51, s57, 3178496
    buffer_load_dwordx4 v1, s[24:27], s51 offen lds
    s_add_u32 m0, s55, 64256
    s_add_u32 s51, s57, 3702784
    buffer_load_dwordx4 v1, s[24:27], s51 offen lds
    s_waitcnt vmcnt(16)
    s_barrier
    s_add_u32 s51, s73, 512
    buffer_load_dwordx4 v[128:131], v2, s[20:23], s51 offen offset:1024
    buffer_load_dwordx4 v[132:135], v2, s[20:23], s51 offen offset:2048
    s_add_u32 m0, s56, 0
    s_add_u32 s51, s58, 128
    buffer_load_dwordx4 v2, s[20:23], s51 offen lds
    s_add_u32 m0, s56, 4224
    s_add_u32 s51, s58, 65664
    buffer_load_dwordx4 v2, s[20:23], s51 offen lds
    s_add_u32 m0, s56, 8448
    s_add_u32 s51, s58, 131200
    buffer_load_dwordx4 v2, s[20:23], s51 offen lds
    s_add_u32 m0, s56, 12672
    s_add_u32 s51, s58, 196736
    buffer_load_dwordx4 v2, s[20:23], s51 offen lds
    s_mov_b32 m0, 16896
    s_add_u32 s51, s49, 262272
    s_mov_b32 exec_hi, 0xffffff
    buffer_load_dwordx4 v2, s[20:23], s51 offen lds
    s_mov_b32 exec_hi, -1
    s_add_u32 m0, s55, 68352
    s_add_u32 s51, s57, 49152
    buffer_load_dwordx4 v1, s[24:27], s51 offen lds
    s_add_u32 m0, s55, 72448
    s_add_u32 s51, s57, 573440
    buffer_load_dwordx4 v1, s[24:27], s51 offen lds
    s_add_u32 m0, s55, 76544
    s_add_u32 s51, s57, 1097728
    buffer_load_dwordx4 v1, s[24:27], s51 offen lds
    s_add_u32 m0, s55, 80640
    s_add_u32 s51, s57, 1622016
    buffer_load_dwordx4 v1, s[24:27], s51 offen lds
    s_add_u32 m0, s55, 84736
    s_add_u32 s51, s57, 2146304
    buffer_load_dwordx4 v1, s[24:27], s51 offen lds
    s_add_u32 m0, s55, 88832
    s_add_u32 s51, s57, 2670592
    buffer_load_dwordx4 v1, s[24:27], s51 offen lds
    s_add_u32 m0, s55, 92928
    s_add_u32 s51, s57, 3194880
    buffer_load_dwordx4 v1, s[24:27], s51 offen lds
    s_add_u32 m0, s55, 97024
    s_add_u32 s51, s57, 3719168
    buffer_load_dwordx4 v1, s[24:27], s51 offen lds
    s_waitcnt vmcnt(24)
    s_barrier
    s_cmp_lg_u32 s69, 0
    s_cbranch_scc1 L_hl0
    s_add_u32 s51, s60, 262144
    buffer_load_dwordx4 v[136:139], v2, s[20:23], s51 offen offset:1024
    buffer_load_dwordx4 v[140:143], v2, s[20:23], s51 offen offset:2048
L_hl0:
    s_add_u32 m0, s55, 101120
    s_add_u32 s51, s57, 294912
    buffer_load_dwordx4 v1, s[24:27], s51 offen lds
    s_add_u32 m0, s55, 105216
    s_add_u32 s51, s57, 819200
    buffer_load_dwordx4 v1, s[24:27], s51 offen lds
    s_add_u32 m0, s55, 109312
    s_add_u32 s51, s57, 1343488
    buffer_load_dwordx4 v1, s[24:27], s51 offen lds
    s_add_u32 m0, s55, 113408
    s_add_u32 s51, s57, 1867776
    buffer_load_dwordx4 v1, s[24:27], s51 offen lds
    s_add_u32 m0, s55, 117504
    s_add_u32 s51, s57, 2392064
    buffer_load_dwordx4 v1, s[24:27], s51 offen lds
    s_add_u32 m0, s55, 121600
    s_add_u32 s51, s57, 2916352
    buffer_load_dwordx4 v1, s[24:27], s51 offen lds
    s_add_u32 m0, s55, 125696
    s_add_u32 s51, s57, 3440640
    buffer_load_dwordx4 v1, s[24:27], s51 offen lds
    s_add_u32 m0, s55, 129792
    s_add_u32 s51, s57, 3964928
    buffer_load_dwordx4 v1, s[24:27], s51 offen lds
    s_waitcnt vmcnt(16)
    s_barrier
    s_add_u32 m0, s56, 17792
    s_add_u32 s51, s58, 1152
    buffer_load_dwordx4 v2, s[20:23], s51 offen lds
    s_add_u32 m0, s56, 22016
    s_add_u32 s51, s58, 66688
    buffer_load_dwordx4 v2, s[20:23], s51 offen lds
    s_add_u32 m0, s56, 26240
    s_add_u32 s51, s58, 132224
    buffer_load_dwordx4 v2, s[20:23], s51 offen lds
    s_add_u32 m0, s56, 30464
    s_add_u32 s51, s58, 197760
    buffer_load_dwordx4 v2, s[20:23], s51 offen lds
    s_mov_b32 m0, 34688
    s_add_u32 s51, s49, 263296
    s_mov_b32 exec_hi, 0xffffff
    buffer_load_dwordx4 v2, s[20:23], s51 offen lds
    s_mov_b32 exec_hi, -1
    s_add_u32 m0, s55, 133888
    s_add_u32 s51, s57, 311296
    buffer_load_dwordx4 v1, s[24:27], s51 offen lds
    s_add_u32 m0, s55, 137984
    s_add_u32 s51, s57, 835584
    buffer_load_dwordx4 v1, s[24:27], s51 offen lds
    s_add_u32 m0, s55, 142080
    s_add_u32 s51, s57, 1359872
    buffer_load_dwordx4 v1, s[24:27], s51 offen lds
    s_add_u32 m0, s55, 146176
    s_add_u32 s51, s57, 1884160
    buffer_load_dwordx4 v1, s[24:27], s51 offen lds
    s_add_u32 m0, s55, 150272
    s_add_u32 s51, s57, 2408448
    buffer_load_dwordx4 v1, s[24:27], s51 offen lds
    s_add_u32 m0, s55, 154368
    s_add_u32 s51, s57, 2932736
    buffer_load_dwordx4 v1, s[24:27], s51 offen lds
    s_add_u32 m0, s55, 158464
    s_add_u32 s51, s57, 3457024
    buffer_load_dwordx4 v1, s[24:27], s51 offen lds
    s_waitcnt vmcnt(63)
    v_lshlrev_b32 v144, 16, v128
    v_and_b32 v145, 0xffff0000, v128
    v_lshlrev_b32 v146, 16, v132
    v_and_b32 v147, 0xffff0000, v132
    v_lshlrev_b32 v148, 16, v129
    v_and_b32 v149, 0xffff0000, v129
    v_lshlrev_b32 v150, 16, v133
    v_and_b32 v151, 0xffff0000, v133
    v_lshlrev_b32 v152, 16, v130
    v_and_b32 v153, 0xffff0000, v130
    v_lshlrev_b32 v154, 16, v134
    v_and_b32 v155, 0xffff0000, v134
    v_lshlrev_b32 v156, 16, v131
    v_and_b32 v157, 0xffff0000, v131
    v_lshlrev_b32 v158, 16, v135
    v_and_b32 v159, 0xffff0000, v135
    v_pk_add_f32 v[144:145], v[144:145], v[146:147] neg_lo:[0,1] neg_hi:[0,1]
    v_pk_add_f32 v[148:149], v[148:149], v[150:151] neg_lo:[0,1] neg_hi:[0,1]
    v_pk_add_f32 v[152:153], v[152:153], v[154:155] neg_lo:[0,1] neg_hi:[0,1]
    v_pk_add_f32 v[156:157], v[156:157], v[158:159] neg_lo:[0,1] neg_hi:[0,1]
    v_cvt_pk_bf16_f32 v164, v144, v145
    v_cvt_pk_bf16_f32 v165, v148, v149
    v_cvt_pk_bf16_f32 v166, v152, v153
    v_cvt_pk_bf16_f32 v167, v156, v157
    s_add_u32 s51, s74, 73728
    buffer_store_dwordx4 v[164:167], v6, s[40:43], s51 offen sc1
    s_waitcnt vmcnt(21)
    s_barrier
    s_add_u32 m0, s55, 35584
    s_add_u32 s51, s57, 3981312
    buffer_load_dwordx4 v1, s[24:27], s51 offen lds
    s_add_u32 m0, s55, 39680
    s_add_u32 s51, s57, 163840
    buffer_load_dwordx4 v1, s[24:27], s51 offen lds
    s_add_u32 m0, s55, 43776
    s_add_u32 s51, s57, 688128
    buffer_load_dwordx4 v1, s[24:27], s51 offen lds
    s_add_u32 m0, s55, 47872
    s_add_u32 s51, s57, 1212416
    buffer_load_dwordx4 v1, s[24:27], s51 offen lds
    s_add_u32 m0, s55, 51968
    s_add_u32 s51, s57, 1736704
    buffer_load_dwordx4 v1, s[24:27], s51 offen lds
    s_add_u32 m0, s55, 56064
    s_add_u32 s51, s57, 2260992
    buffer_load_dwordx4 v1, s[24:27], s51 offen lds
    s_add_u32 m0, s55, 60160
    s_add_u32 s51, s57, 2785280
    buffer_load_dwordx4 v1, s[24:27], s51 offen lds
    s_add_u32 m0, s55, 64256
    s_add_u32 s51, s57, 3309568
    buffer_load_dwordx4 v1, s[24:27], s51 offen lds
    s_cmp_lg_u32 s69, 0
    s_cbranch_scc1 L_hf0
    s_waitcnt vmcnt(29)
    v_lshlrev_b32 v144, 16, v136
    v_and_b32 v145, 0xffff0000, v136
    v_lshlrev_b32 v146, 16, v140
    v_and_b32 v147, 0xffff0000, v140
    v_lshlrev_b32 v148, 16, v137
    v_and_b32 v149, 0xffff0000, v137
    v_lshlrev_b32 v150, 16, v141
    v_and_b32 v151, 0xffff0000, v141
    v_lshlrev_b32 v152, 16, v138
    v_and_b32 v153, 0xffff0000, v138
    v_lshlrev_b32 v154, 16, v142
    v_and_b32 v155, 0xffff0000, v142
    v_lshlrev_b32 v156, 16, v139
    v_and_b32 v157, 0xffff0000, v139
    v_lshlrev_b32 v158, 16, v143
    v_and_b32 v159, 0xffff0000, v143
    v_pk_add_f32 v[144:145], v[144:145], v[146:147] neg_lo:[0,1] neg_hi:[0,1]
    v_pk_add_f32 v[148:149], v[148:149], v[150:151] neg_lo:[0,1] neg_hi:[0,1]
    v_pk_add_f32 v[152:153], v[152:153], v[154:155] neg_lo:[0,1] neg_hi:[0,1]
    v_pk_add_f32 v[156:157], v[156:157], v[158:159] neg_lo:[0,1] neg_hi:[0,1]
    v_cvt_pk_bf16_f32 v168, v144, v145
    v_cvt_pk_bf16_f32 v169, v148, v149
    v_cvt_pk_bf16_f32 v170, v152, v153
    v_cvt_pk_bf16_f32 v171, v156, v157
    s_add_u32 s51, s61, 8192
    buffer_store_dwordx4 v[168:171], v5, s[40:43], s51 offen sc1
L_hf0:
    s_waitcnt vmcnt(16)
    s_barrier
    s_add_u32 s51, s73, 128
    buffer_load_dwordx4 v[120:123], v2, s[20:23], s51 offen offset:1024
    buffer_load_dwordx4 v[124:127], v2, s[20:23], s51 offen offset:2048
    s_add_u32 m0, s56, 0
    s_add_u32 s51, s58, 640
    buffer_load_dwordx4 v2, s[20:23], s51 offen lds
    s_add_u32 m0, s56, 4224
    s_add_u32 s51, s58, 66176
    buffer_load_dwordx4 v2, s[20:23], s51 offen lds
    s_add_u32 m0, s56, 8448
    s_add_u32 s51, s58, 131712
    buffer_load_dwordx4 v2, s[20:23], s51 offen lds
    s_add_u32 m0, s56, 12672
    s_add_u32 s51, s58, 197248
    buffer_load_dwordx4 v2, s[20:23], s51 offen lds
    s_mov_b32 m0, 16896
    s_add_u32 s51, s49, 262784
    s_mov_b32 exec_hi, 0xffffff
    buffer_load_dwordx4 v2, s[20:23], s51 offen lds
    s_mov_b32 exec_hi, -1
    s_add_u32 m0, s55, 68352
    s_add_u32 s51, s57, 3833856
    buffer_load_dwordx4 v1, s[24:27], s51 offen lds
    s_add_u32 m0, s55, 72448
    s_add_u32 s51, s57, 180224
    buffer_load_dwordx4 v1, s[24:27], s51 offen lds
    s_add_u32 m0, s55, 76544
    s_add_u32 s51, s57, 704512
    buffer_load_dwordx4 v1, s[24:27], s51 offen lds
    s_add_u32 m0, s55, 80640
    s_add_u32 s51, s57, 1228800
    buffer_load_dwordx4 v1, s[24:27], s51 offen lds
    s_add_u32 m0, s55, 84736
    s_add_u32 s51, s57, 1753088
    buffer_load_dwordx4 v1, s[24:27], s51 offen lds
    s_add_u32 m0, s55, 88832
    s_add_u32 s51, s57, 2277376
    buffer_load_dwordx4 v1, s[24:27], s51 offen lds
    s_add_u32 m0, s55, 92928
    s_add_u32 s51, s57, 2801664
    buffer_load_dwordx4 v1, s[24:27], s51 offen lds
    s_add_u32 m0, s55, 97024
    s_add_u32 s51, s57, 3325952
    buffer_load_dwordx4 v1, s[24:27], s51 offen lds
    s_waitcnt vmcnt(22)
    s_barrier
    s_add_u32 m0, s55, 101120
    s_add_u32 s51, s57, 3850240
    buffer_load_dwordx4 v1, s[24:27], s51 offen lds
    s_add_u32 m0, s55, 105216
    s_add_u32 s51, s57, 425984
    buffer_load_dwordx4 v1, s[24:27], s51 offen lds
    s_add_u32 m0, s55, 109312
    s_add_u32 s51, s57, 950272
    buffer_load_dwordx4 v1, s[24:27], s51 offen lds
    s_add_u32 m0, s55, 113408
    s_add_u32 s51, s57, 1474560
    buffer_load_dwordx4 v1, s[24:27], s51 offen lds
    s_add_u32 m0, s55, 117504
    s_add_u32 s51, s57, 1998848
    buffer_load_dwordx4 v1, s[24:27], s51 offen lds
    s_add_u32 m0, s55, 121600
    s_add_u32 s51, s57, 2523136
    buffer_load_dwordx4 v1, s[24:27], s51 offen lds
    s_add_u32 m0, s55, 125696
    s_add_u32 s51, s57, 3047424
    buffer_load_dwordx4 v1, s[24:27], s51 offen lds
    s_add_u32 m0, s55, 129792
    s_add_u32 s51, s57, 3571712
    buffer_load_dwordx4 v1, s[24:27], s51 offen lds
    s_waitcnt vmcnt(23)
    s_waitcnt vmcnt(15)
    s_barrier
    s_add_u32 m0, s56, 17792
    s_add_u32 s51, s58, 1664
    buffer_load_dwordx4 v2, s[20:23], s51 offen lds
    s_add_u32 m0, s56, 22016
    s_add_u32 s51, s58, 67200
    buffer_load_dwordx4 v2, s[20:23], s51 offen lds
    s_add_u32 m0, s56, 26240
    s_add_u32 s51, s58, 132736
    buffer_load_dwordx4 v2, s[20:23], s51 offen lds
    s_add_u32 m0, s56, 30464
    s_add_u32 s51, s58, 198272
    buffer_load_dwordx4 v2, s[20:23], s51 offen lds
    s_mov_b32 m0, 34688
    s_add_u32 s51, s49, 263808
    s_mov_b32 exec_hi, 0xffffff
    buffer_load_dwordx4 v2, s[20:23], s51 offen lds
    s_mov_b32 exec_hi, -1
    s_add_u32 m0, s55, 133888
    s_add_u32 s51, s57, 442368
    buffer_load_dwordx4 v1, s[24:27], s51 offen lds
    s_add_u32 m0, s55, 137984
    s_add_u32 s51, s57, 966656
    buffer_load_dwordx4 v1, s[24:27], s51 offen lds
    s_add_u32 m0, s55, 142080
    s_add_u32 s51, s57, 1490944
    buffer_load_dwordx4 v1, s[24:27], s51 offen lds
    s_add_u32 m0, s55, 146176
    s_add_u32 s51, s57, 2015232
    buffer_load_dwordx4 v1, s[24:27], s51 offen lds
    s_add_u32 m0, s55, 150272
    s_add_u32 s51, s57, 2539520
    buffer_load_dwordx4 v1, s[24:27], s51 offen lds
    s_add_u32 m0, s55, 154368
    s_add_u32 s51, s57, 3063808
    buffer_load_dwordx4 v1, s[24:27], s51 offen lds
    s_add_u32 m0, s55, 158464
    s_add_u32 s51, s57, 3588096
    buffer_load_dwordx4 v1, s[24:27], s51 offen lds
    s_waitcnt vmcnt(63)
    v_lshlrev_b32 v144, 16, v120
    v_and_b32 v145, 0xffff0000, v120
    v_lshlrev_b32 v146, 16, v124
    v_and_b32 v147, 0xffff0000, v124
    v_lshlrev_b32 v148, 16, v121
    v_and_b32 v149, 0xffff0000, v121
    v_lshlrev_b32 v150, 16, v125
    v_and_b32 v151, 0xffff0000, v125
    v_lshlrev_b32 v152, 16, v122
    v_and_b32 v153, 0xffff0000, v122
    v_lshlrev_b32 v154, 16, v126
    v_and_b32 v155, 0xffff0000, v126
    v_lshlrev_b32 v156, 16, v123
    v_and_b32 v157, 0xffff0000, v123
    v_lshlrev_b32 v158, 16, v127
    v_and_b32 v159, 0xffff0000, v127
    v_pk_add_f32 v[144:145], v[144:145], v[146:147] neg_lo:[0,1] neg_hi:[0,1]
    v_pk_add_f32 v[148:149], v[148:149], v[150:151] neg_lo:[0,1] neg_hi:[0,1]
    v_pk_add_f32 v[152:153], v[152:153], v[154:155] neg_lo:[0,1] neg_hi:[0,1]
    v_pk_add_f32 v[156:157], v[156:157], v[158:159] neg_lo:[0,1] neg_hi:[0,1]
    v_cvt_pk_bf16_f32 v160, v144, v145
    v_cvt_pk_bf16_f32 v161, v148, v149
    v_cvt_pk_bf16_f32 v162, v152, v153
    v_cvt_pk_bf16_f32 v163, v156, v157
    s_add_u32 s51, s74, 18432
    buffer_store_dwordx4 v[160:163], v6, s[40:43], s51 offen sc1
    s_waitcnt vmcnt(20)
    s_barrier
    s_add_u32 m0, s55, 35584
    s_add_u32 s51, s57, 65536
    buffer_load_dwordx4 v1, s[24:27], s51 offen lds
    s_add_u32 m0, s55, 39680
    s_add_u32 s51, s57, 589824
    buffer_load_dwordx4 v1, s[24:27], s51 offen lds
    s_add_u32 m0, s55, 43776
    s_add_u32 s51, s57, 1114112
    buffer_load_dwordx4 v1, s[24:27], s51 offen lds
    s_add_u32 m0, s55, 47872
    s_add_u32 s51, s57, 1638400
    buffer_load_dwordx4 v1, s[24:27], s51 offen lds
    s_add_u32 m0, s55, 51968
    s_add_u32 s51, s57, 2162688
    buffer_load_dwordx4 v1, s[24:27], s51 offen lds
    s_add_u32 m0, s55, 56064
    s_add_u32 s51, s57, 2686976
    buffer_load_dwordx4 v1, s[24:27], s51 offen lds
    s_add_u32 m0, s55, 60160
    s_add_u32 s51, s57, 3211264
    buffer_load_dwordx4 v1, s[24:27], s51 offen lds
    s_add_u32 m0, s55, 64256
    s_add_u32 s51, s57, 3735552
    buffer_load_dwordx4 v1, s[24:27], s51 offen lds
    s_waitcnt vmcnt(16)
    s_barrier
    s_add_u32 s51, s73, 640
    buffer_load_dwordx4 v[128:131], v2, s[20:23], s51 offen offset:1024
    buffer_load_dwordx4 v[132:135], v2, s[20:23], s51 offen offset:2048
    s_add_u32 m0, s56, 0
    s_add_u32 s51, s58, 256
    buffer_load_dwordx4 v2, s[20:23], s51 offen lds
    s_add_u32 m0, s56, 4224
    s_add_u32 s51, s58, 65792
    buffer_load_dwordx4 v2, s[20:23], s51 offen lds
    s_add_u32 m0, s56, 8448
    s_add_u32 s51, s58, 131328
    buffer_load_dwordx4 v2, s[20:23], s51 offen lds
    s_add_u32 m0, s56, 12672
    s_add_u32 s51, s58, 196864
    buffer_load_dwordx4 v2, s[20:23], s51 offen lds
    s_mov_b32 m0, 16896
    s_add_u32 s51, s49, 262400
    s_mov_b32 exec_hi, 0xffffff
    buffer_load_dwordx4 v2, s[20:23], s51 offen lds
    s_mov_b32 exec_hi, -1
    s_add_u32 m0, s55, 68352
    s_add_u32 s51, s57, 81920
    buffer_load_dwordx4 v1, s[24:27], s51 offen lds
    s_add_u32 m0, s55, 72448
    s_add_u32 s51, s57, 606208
    buffer_load_dwordx4 v1, s[24:27], s51 offen lds
    s_add_u32 m0, s55, 76544
    s_add_u32 s51, s57, 1130496
    buffer_load_dwordx4 v1, s[24:27], s51 offen lds
    s_add_u32 m0, s55, 80640
    s_add_u32 s51, s57, 1654784
    buffer_load_dwordx4 v1, s[24:27], s51 offen lds
    s_add_u32 m0, s55, 84736
    s_add_u32 s51, s57, 2179072
    buffer_load_dwordx4 v1, s[24:27], s51 offen lds
    s_add_u32 m0, s55, 88832
    s_add_u32 s51, s57, 2703360
    buffer_load_dwordx4 v1, s[24:27], s51 offen lds
    s_add_u32 m0, s55, 92928
    s_add_u32 s51, s57, 3227648
    buffer_load_dwordx4 v1, s[24:27], s51 offen lds
    s_add_u32 m0, s55, 97024
    s_add_u32 s51, s57, 3751936
    buffer_load_dwordx4 v1, s[24:27], s51 offen lds
    s_waitcnt vmcnt(24)
    s_barrier
    s_cmp_lg_u32 s69, 1
    s_cbranch_scc1 L_hl1
    s_add_u32 s51, s60, 262272
    buffer_load_dwordx4 v[136:139], v2, s[20:23], s51 offen offset:1024
    buffer_load_dwordx4 v[140:143], v2, s[20:23], s51 offen offset:2048
L_hl1:
    s_add_u32 m0, s55, 101120
    s_add_u32 s51, s57, 327680
    buffer_load_dwordx4 v1, s[24:27], s51 offen lds
    s_add_u32 m0, s55, 105216
    s_add_u32 s51, s57, 851968
    buffer_load_dwordx4 v1, s[24:27], s51 offen lds
    s_add_u32 m0, s55, 109312
    s_add_u32 s51, s57, 1376256
    buffer_load_dwordx4 v1, s[24:27], s51 offen lds
    s_add_u32 m0, s55, 113408
    s_add_u32 s51, s57, 1900544
    buffer_load_dwordx4 v1, s[24:27], s51 offen lds
    s_add_u32 m0, s55, 117504
    s_add_u32 s51, s57, 2424832
    buffer_load_dwordx4 v1, s[24:27], s51 offen lds
    s_add_u32 m0, s55, 121600
    s_add_u32 s51, s57, 2949120
    buffer_load_dwordx4 v1, s[24:27], s51 offen lds
    s_add_u32 m0, s55, 125696
    s_add_u32 s51, s57, 3473408
    buffer_load_dwordx4 v1, s[24:27], s51 offen lds
    s_add_u32 m0, s55, 129792
    s_add_u32 s51, s57, 3997696
    buffer_load_dwordx4 v1, s[24:27], s51 offen lds
    s_waitcnt vmcnt(16)
    s_barrier
    s_add_u32 m0, s56, 17792
    s_add_u32 s51, s58, 1280
    buffer_load_dwordx4 v2, s[20:23], s51 offen lds
    s_add_u32 m0, s56, 22016
    s_add_u32 s51, s58, 66816
    buffer_load_dwordx4 v2, s[20:23], s51 offen lds
    s_add_u32 m0, s56, 26240
    s_add_u32 s51, s58, 132352
    buffer_load_dwordx4 v2, s[20:23], s51 offen lds
    s_add_u32 m0, s56, 30464
    s_add_u32 s51, s58, 197888
    buffer_load_dwordx4 v2, s[20:23], s51 offen lds
    s_mov_b32 m0, 34688
    s_add_u32 s51, s49, 263424
    s_mov_b32 exec_hi, 0xffffff
    buffer_load_dwordx4 v2, s[20:23], s51 offen lds
    s_mov_b32 exec_hi, -1
    s_add_u32 m0, s55, 133888
    s_add_u32 s51, s57, 344064
    buffer_load_dwordx4 v1, s[24:27], s51 offen lds
    s_add_u32 m0, s55, 137984
    s_add_u32 s51, s57, 868352
    buffer_load_dwordx4 v1, s[24:27], s51 offen lds
    s_add_u32 m0, s55, 142080
    s_add_u32 s51, s57, 1392640
    buffer_load_dwordx4 v1, s[24:27], s51 offen lds
    s_add_u32 m0, s55, 146176
    s_add_u32 s51, s57, 1916928
    buffer_load_dwordx4 v1, s[24:27], s51 offen lds
    s_add_u32 m0, s55, 150272
    s_add_u32 s51, s57, 2441216
    buffer_load_dwordx4 v1, s[24:27], s51 offen lds
    s_add_u32 m0, s55, 154368
    s_add_u32 s51, s57, 2965504
    buffer_load_dwordx4 v1, s[24:27], s51 offen lds
    s_add_u32 m0, s55, 158464
    s_add_u32 s51, s57, 3489792
    buffer_load_dwordx4 v1, s[24:27], s51 offen lds
    s_waitcnt vmcnt(63)
    v_lshlrev_b32 v144, 16, v128
    v_and_b32 v145, 0xffff0000, v128
    v_lshlrev_b32 v146, 16, v132
    v_and_b32 v147, 0xffff0000, v132
    v_lshlrev_b32 v148, 16, v129
    v_and_b32 v149, 0xffff0000, v129
    v_lshlrev_b32 v150, 16, v133
    v_and_b32 v151, 0xffff0000, v133
    v_lshlrev_b32 v152, 16, v130
    v_and_b32 v153, 0xffff0000, v130
    v_lshlrev_b32 v154, 16, v134
    v_and_b32 v155, 0xffff0000, v134
    v_lshlrev_b32 v156, 16, v131
    v_and_b32 v157, 0xffff0000, v131
    v_lshlrev_b32 v158, 16, v135
    v_and_b32 v159, 0xffff0000, v135
    v_pk_add_f32 v[144:145], v[144:145], v[146:147] neg_lo:[0,1] neg_hi:[0,1]
    v_pk_add_f32 v[148:149], v[148:149], v[150:151] neg_lo:[0,1] neg_hi:[0,1]
    v_pk_add_f32 v[152:153], v[152:153], v[154:155] neg_lo:[0,1] neg_hi:[0,1]
    v_pk_add_f32 v[156:157], v[156:157], v[158:159] neg_lo:[0,1] neg_hi:[0,1]
    v_cvt_pk_bf16_f32 v164, v144, v145
    v_cvt_pk_bf16_f32 v165, v148, v149
    v_cvt_pk_bf16_f32 v166, v152, v153
    v_cvt_pk_bf16_f32 v167, v156, v157
    s_add_u32 s51, s74, 92160
    buffer_store_dwordx4 v[164:167], v6, s[40:43], s51 offen sc1
    s_waitcnt vmcnt(21)
    s_barrier
    s_add_u32 m0, s55, 35584
    s_add_u32 s51, s57, 4014080
    buffer_load_dwordx4 v1, s[24:27], s51 offen lds
    s_add_u32 m0, s55, 39680
    s_add_u32 s51, s57, 196608
    buffer_load_dwordx4 v1, s[24:27], s51 offen lds
    s_add_u32 m0, s55, 43776
    s_add_u32 s51, s57, 720896
    buffer_load_dwordx4 v1, s[24:27], s51 offen lds
    s_add_u32 m0, s55, 47872
    s_add_u32 s51, s57, 1245184
    buffer_load_dwordx4 v1, s[24:27], s51 offen lds
    s_add_u32 m0, s55, 51968
    s_add_u32 s51, s57, 1769472
    buffer_load_dwordx4 v1, s[24:27], s51 offen lds
    s_add_u32 m0, s55, 56064
    s_add_u32 s51, s57, 2293760
    buffer_load_dwordx4 v1, s[24:27], s51 offen lds
    s_add_u32 m0, s55, 60160
    s_add_u32 s51, s57, 2818048
    buffer_load_dwordx4 v1, s[24:27], s51 offen lds
    s_add_u32 m0, s55, 64256
    s_add_u32 s51, s57, 3342336
    buffer_load_dwordx4 v1, s[24:27], s51 offen lds
    s_cmp_lg_u32 s69, 1
    s_cbranch_scc1 L_hf1
    s_waitcnt vmcnt(29)
    v_lshlrev_b32 v144, 16, v136
    v_and_b32 v145, 0xffff0000, v136
    v_lshlrev_b32 v146, 16, v140
    v_and_b32 v147, 0xffff0000, v140
    v_lshlrev_b32 v148, 16, v137
    v_and_b32 v149, 0xffff0000, v137
    v_lshlrev_b32 v150, 16, v141
    v_and_b32 v151, 0xffff0000, v141
    v_lshlrev_b32 v152, 16, v138
    v_and_b32 v153, 0xffff0000, v138
    v_lshlrev_b32 v154, 16, v142
    v_and_b32 v155, 0xffff0000, v142
    v_lshlrev_b32 v156, 16, v139
    v_and_b32 v157, 0xffff0000, v139
    v_lshlrev_b32 v158, 16, v143
    v_and_b32 v159, 0xffff0000, v143
    v_pk_add_f32 v[144:145], v[144:145], v[146:147] neg_lo:[0,1] neg_hi:[0,1]
    v_pk_add_f32 v[148:149], v[148:149], v[150:151] neg_lo:[0,1] neg_hi:[0,1]
    v_pk_add_f32 v[152:153], v[152:153], v[154:155] neg_lo:[0,1] neg_hi:[0,1]
    v_pk_add_f32 v[156:157], v[156:157], v[158:159] neg_lo:[0,1] neg_hi:[0,1]
    v_cvt_pk_bf16_f32 v168, v144, v145
    v_cvt_pk_bf16_f32 v169, v148, v149
    v_cvt_pk_bf16_f32 v170, v152, v153
    v_cvt_pk_bf16_f32 v171, v156, v157
    s_add_u32 s51, s61, 26624
    buffer_store_dwordx4 v[168:171], v5, s[40:43], s51 offen sc1
L_hf1:
    s_waitcnt vmcnt(16)
    s_barrier
    s_add_u32 s51, s73, 256
    buffer_load_dwordx4 v[120:123], v2, s[20:23], s51 offen offset:1024
    buffer_load_dwordx4 v[124:127], v2, s[20:23], s51 offen offset:2048
    s_add_u32 m0, s56, 0
    s_add_u32 s51, s58, 768
    buffer_load_dwordx4 v2, s[20:23], s51 offen lds
    s_add_u32 m0, s56, 4224
    s_add_u32 s51, s58, 66304
    buffer_load_dwordx4 v2, s[20:23], s51 offen lds
    s_add_u32 m0, s56, 8448
    s_add_u32 s51, s58, 131840
    buffer_load_dwordx4 v2, s[20:23], s51 offen lds
    s_add_u32 m0, s56, 12672
    s_add_u32 s51, s58, 197376
    buffer_load_dwordx4 v2, s[20:23], s51 offen lds
    s_mov_b32 m0, 16896
    s_add_u32 s51, s49, 262912
    s_mov_b32 exec_hi, 0xffffff
    buffer_load_dwordx4 v2, s[20:23], s51 offen lds
    s_mov_b32 exec_hi, -1
    s_add_u32 m0, s55, 68352
    s_add_u32 s51, s57, 3866624
    buffer_load_dwordx4 v1, s[24:27], s51 offen lds
    s_add_u32 m0, s55, 72448
    s_add_u32 s51, s57, 212992
    buffer_load_dwordx4 v1, s[24:27], s51 offen lds
    s_add_u32 m0, s55, 76544
    s_add_u32 s51, s57, 737280
    buffer_load_dwordx4 v1, s[24:27], s51 offen lds
    s_add_u32 m0, s55, 80640
    s_add_u32 s51, s57, 1261568
    buffer_load_dwordx4 v1, s[24:27], s51 offen lds
    s_add_u32 m0, s55, 84736
    s_add_u32 s51, s57, 1785856
    buffer_load_dwordx4 v1, s[24:27], s51 offen lds
    s_add_u32 m0, s55, 88832
    s_add_u32 s51, s57, 2310144
    buffer_load_dwordx4 v1, s[24:27], s51 offen lds
    s_add_u32 m0, s55, 92928
    s_add_u32 s51, s57, 2834432
    buffer_load_dwordx4 v1, s[24:27], s51 offen lds
    s_add_u32 m0, s55, 97024
    s_add_u32 s51, s57, 3358720
    buffer_load_dwordx4 v1, s[24:27], s51 offen lds
    s_waitcnt vmcnt(22)
    s_barrier
    s_add_u32 m0, s55, 101120
    s_add_u32 s51, s57, 3883008
    buffer_load_dwordx4 v1, s[24:27], s51 offen lds
    s_add_u32 m0, s55, 105216
    s_add_u32 s51, s57, 458752
    buffer_load_dwordx4 v1, s[24:27], s51 offen lds
    s_add_u32 m0, s55, 109312
    s_add_u32 s51, s57, 983040
    buffer_load_dwordx4 v1, s[24:27], s51 offen lds
    s_add_u32 m0, s55, 113408
    s_add_u32 s51, s57, 1507328
    buffer_load_dwordx4 v1, s[24:27], s51 offen lds
    s_add_u32 m0, s55, 117504
    s_add_u32 s51, s57, 2031616
    buffer_load_dwordx4 v1, s[24:27], s51 offen lds
    s_add_u32 m0, s55, 121600
    s_add_u32 s51, s57, 2555904
    buffer_load_dwordx4 v1, s[24:27], s51 offen lds
    s_add_u32 m0, s55, 125696
    s_add_u32 s51, s57, 3080192
    buffer_load_dwordx4 v1, s[24:27], s51 offen lds
    s_add_u32 m0, s55, 129792
    s_add_u32 s51, s57, 3604480
    buffer_load_dwordx4 v1, s[24:27], s51 offen lds
    s_waitcnt vmcnt(23)
    s_waitcnt vmcnt(15)
    s_barrier
    s_add_u32 m0, s56, 17792
    s_add_u32 s51, s58, 1792
    buffer_load_dwordx4 v2, s[20:23], s51 offen lds
    s_add_u32 m0, s56, 22016
    s_add_u32 s51, s58, 67328
    buffer_load_dwordx4 v2, s[20:23], s51 offen lds
    s_add_u32 m0, s56, 26240
    s_add_u32 s51, s58, 132864
    buffer_load_dwordx4 v2, s[20:23], s51 offen lds
    s_add_u32 m0, s56, 30464
    s_add_u32 s51, s58, 198400
    buffer_load_dwordx4 v2, s[20:23], s51 offen lds
    s_mov_b32 m0, 34688
    s_add_u32 s51, s49, 263936
    s_mov_b32 exec_hi, 0xffffff
    buffer_load_dwordx4 v2, s[20:23], s51 offen lds
    s_mov_b32 exec_hi, -1
    s_add_u32 m0, s55, 133888
    s_add_u32 s51, s57, 475136
    buffer_load_dwordx4 v1, s[24:27], s51 offen lds
    s_add_u32 m0, s55, 137984
    s_add_u32 s51, s57, 999424
    buffer_load_dwordx4 v1, s[24:27], s51 offen lds
    s_add_u32 m0, s55, 142080
    s_add_u32 s51, s57, 1523712
    buffer_load_dwordx4 v1, s[24:27], s51 offen lds
    s_add_u32 m0, s55, 146176
    s_add_u32 s51, s57, 2048000
    buffer_load_dwordx4 v1, s[24:27], s51 offen lds
    s_add_u32 m0, s55, 150272
    s_add_u32 s51, s57, 2572288
    buffer_load_dwordx4 v1, s[24:27], s51 offen lds
    s_add_u32 m0, s55, 154368
    s_add_u32 s51, s57, 3096576
    buffer_load_dwordx4 v1, s[24:27], s51 offen lds
    s_add_u32 m0, s55, 158464
    s_add_u32 s51, s57, 3620864
    buffer_load_dwordx4 v1, s[24:27], s51 offen lds
    s_waitcnt vmcnt(63)
    v_lshlrev_b32 v144, 16, v120
    v_and_b32 v145, 0xffff0000, v120
    v_lshlrev_b32 v146, 16, v124
    v_and_b32 v147, 0xffff0000, v124
    v_lshlrev_b32 v148, 16, v121
    v_and_b32 v149, 0xffff0000, v121
    v_lshlrev_b32 v150, 16, v125
    v_and_b32 v151, 0xffff0000, v125
    v_lshlrev_b32 v152, 16, v122
    v_and_b32 v153, 0xffff0000, v122
    v_lshlrev_b32 v154, 16, v126
    v_and_b32 v155, 0xffff0000, v126
    v_lshlrev_b32 v156, 16, v123
    v_and_b32 v157, 0xffff0000, v123
    v_lshlrev_b32 v158, 16, v127
    v_and_b32 v159, 0xffff0000, v127
    v_pk_add_f32 v[144:145], v[144:145], v[146:147] neg_lo:[0,1] neg_hi:[0,1]
    v_pk_add_f32 v[148:149], v[148:149], v[150:151] neg_lo:[0,1] neg_hi:[0,1]
    v_pk_add_f32 v[152:153], v[152:153], v[154:155] neg_lo:[0,1] neg_hi:[0,1]
    v_pk_add_f32 v[156:157], v[156:157], v[158:159] neg_lo:[0,1] neg_hi:[0,1]
    v_cvt_pk_bf16_f32 v160, v144, v145
    v_cvt_pk_bf16_f32 v161, v148, v149
    v_cvt_pk_bf16_f32 v162, v152, v153
    v_cvt_pk_bf16_f32 v163, v156, v157
    s_add_u32 s51, s74, 36864
    buffer_store_dwordx4 v[160:163], v6, s[40:43], s51 offen sc1
    s_waitcnt vmcnt(20)
    s_barrier
    s_add_u32 m0, s55, 35584
    s_add_u32 s51, s57, 98304
    buffer_load_dwordx4 v1, s[24:27], s51 offen lds
    s_add_u32 m0, s55, 39680
    s_add_u32 s51, s57, 622592
    buffer_load_dwordx4 v1, s[24:27], s51 offen lds
    s_add_u32 m0, s55, 43776
    s_add_u32 s51, s57, 1146880
    buffer_load_dwordx4 v1, s[24:27], s51 offen lds
    s_add_u32 m0, s55, 47872
    s_add_u32 s51, s57, 1671168
    buffer_load_dwordx4 v1, s[24:27], s51 offen lds
    s_add_u32 m0, s55, 51968
    s_add_u32 s51, s57, 2195456
    buffer_load_dwordx4 v1, s[24:27], s51 offen lds
    s_add_u32 m0, s55, 56064
    s_add_u32 s51, s57, 2719744
    buffer_load_dwordx4 v1, s[24:27], s51 offen lds
    s_add_u32 m0, s55, 60160
    s_add_u32 s51, s57, 3244032
    buffer_load_dwordx4 v1, s[24:27], s51 offen lds
    s_add_u32 m0, s55, 64256
    s_add_u32 s51, s57, 3768320
    buffer_load_dwordx4 v1, s[24:27], s51 offen lds
    s_waitcnt vmcnt(16)
    s_barrier
    s_add_u32 s51, s73, 768
    buffer_load_dwordx4 v[128:131], v2, s[20:23], s51 offen offset:1024
    buffer_load_dwordx4 v[132:135], v2, s[20:23], s51 offen offset:2048
    s_add_u32 m0, s56, 0
    s_add_u32 s51, s58, 384
    buffer_load_dwordx4 v2, s[20:23], s51 offen lds
    s_add_u32 m0, s56, 4224
    s_add_u32 s51, s58, 65920
    buffer_load_dwordx4 v2, s[20:23], s51 offen lds
    s_add_u32 m0, s56, 8448
    s_add_u32 s51, s58, 131456
    buffer_load_dwordx4 v2, s[20:23], s51 offen lds
    s_add_u32 m0, s56, 12672
    s_add_u32 s51, s58, 196992
    buffer_load_dwordx4 v2, s[20:23], s51 offen lds
    s_mov_b32 m0, 16896
    s_add_u32 s51, s49, 262528
    s_mov_b32 exec_hi, 0xffffff
    buffer_load_dwordx4 v2, s[20:23], s51 offen lds
    s_mov_b32 exec_hi, -1
    s_add_u32 m0, s55, 68352
    s_add_u32 s51, s57, 114688
    buffer_load_dwordx4 v1, s[24:27], s51 offen lds
    s_add_u32 m0, s55, 72448
    s_add_u32 s51, s57, 638976
    buffer_load_dwordx4 v1, s[24:27], s51 offen lds
    s_add_u32 m0, s55, 76544
    s_add_u32 s51, s57, 1163264
    buffer_load_dwordx4 v1, s[24:27], s51 offen lds
    s_add_u32 m0, s55, 80640
    s_add_u32 s51, s57, 1687552
    buffer_load_dwordx4 v1, s[24:27], s51 offen lds
    s_add_u32 m0, s55, 84736
    s_add_u32 s51, s57, 2211840
    buffer_load_dwordx4 v1, s[24:27], s51 offen lds
    s_add_u32 m0, s55, 88832
    s_add_u32 s51, s57, 2736128
    buffer_load_dwordx4 v1, s[24:27], s51 offen lds
    s_add_u32 m0, s55, 92928
    s_add_u32 s51, s57, 3260416
    buffer_load_dwordx4 v1, s[24:27], s51 offen lds
    s_add_u32 m0, s55, 97024
    s_add_u32 s51, s57, 3784704
    buffer_load_dwordx4 v1, s[24:27], s51 offen lds
    s_waitcnt vmcnt(24)
    s_barrier
    s_cmp_lg_u32 s69, 2
    s_cbranch_scc1 L_hl2
    s_add_u32 s51, s60, 262400
    buffer_load_dwordx4 v[136:139], v2, s[20:23], s51 offen offset:1024
    buffer_load_dwordx4 v[140:143], v2, s[20:23], s51 offen offset:2048
L_hl2:
    s_add_u32 m0, s55, 101120
    s_add_u32 s51, s57, 360448
    buffer_load_dwordx4 v1, s[24:27], s51 offen lds
    s_add_u32 m0, s55, 105216
    s_add_u32 s51, s57, 884736
    buffer_load_dwordx4 v1, s[24:27], s51 offen lds
    s_add_u32 m0, s55, 109312
    s_add_u32 s51, s57, 1409024
    buffer_load_dwordx4 v1, s[24:27], s51 offen lds
    s_add_u32 m0, s55, 113408
    s_add_u32 s51, s57, 1933312
    buffer_load_dwordx4 v1, s[24:27], s51 offen lds
    s_add_u32 m0, s55, 117504
    s_add_u32 s51, s57, 2457600
    buffer_load_dwordx4 v1, s[24:27], s51 offen lds
    s_add_u32 m0, s55, 121600
    s_add_u32 s51, s57, 2981888
    buffer_load_dwordx4 v1, s[24:27], s51 offen lds
    s_add_u32 m0, s55, 125696
    s_add_u32 s51, s57, 3506176
    buffer_load_dwordx4 v1, s[24:27], s51 offen lds
    s_add_u32 m0, s55, 129792
    s_add_u32 s51, s57, 4030464
    buffer_load_dwordx4 v1, s[24:27], s51 offen lds
    s_waitcnt vmcnt(16)
    s_barrier
    s_add_u32 m0, s56, 17792
    s_add_u32 s51, s58, 1408
    buffer_load_dwordx4 v2, s[20:23], s51 offen lds
    s_add_u32 m0, s56, 22016
    s_add_u32 s51, s58, 66944
    buffer_load_dwordx4 v2, s[20:23], s51 offen lds
    s_add_u32 m0, s56, 26240
    s_add_u32 s51, s58, 132480
    buffer_load_dwordx4 v2, s[20:23], s51 offen lds
    s_add_u32 m0, s56, 30464
    s_add_u32 s51, s58, 198016
    buffer_load_dwordx4 v2, s[20:23], s51 offen lds
    s_mov_b32 m0, 34688
    s_add_u32 s51, s49, 263552
    s_mov_b32 exec_hi, 0xffffff
    buffer_load_dwordx4 v2, s[20:23], s51 offen lds
    s_mov_b32 exec_hi, -1
    s_add_u32 m0, s55, 133888
    s_add_u32 s51, s57, 376832
    buffer_load_dwordx4 v1, s[24:27], s51 offen lds
    s_add_u32 m0, s55, 137984
    s_add_u32 s51, s57, 901120
    buffer_load_dwordx4 v1, s[24:27], s51 offen lds
    s_add_u32 m0, s55, 142080
    s_add_u32 s51, s57, 1425408
    buffer_load_dwordx4 v1, s[24:27], s51 offen lds
    s_add_u32 m0, s55, 146176
    s_add_u32 s51, s57, 1949696
    buffer_load_dwordx4 v1, s[24:27], s51 offen lds
    s_add_u32 m0, s55, 150272
    s_add_u32 s51, s57, 2473984
    buffer_load_dwordx4 v1, s[24:27], s51 offen lds
    s_add_u32 m0, s55, 154368
    s_add_u32 s51, s57, 2998272
    buffer_load_dwordx4 v1, s[24:27], s51 offen lds
    s_add_u32 m0, s55, 158464
    s_add_u32 s51, s57, 3522560
    buffer_load_dwordx4 v1, s[24:27], s51 offen lds
    s_waitcnt vmcnt(63)
    v_lshlrev_b32 v144, 16, v128
    v_and_b32 v145, 0xffff0000, v128
    v_lshlrev_b32 v146, 16, v132
    v_and_b32 v147, 0xffff0000, v132
    v_lshlrev_b32 v148, 16, v129
    v_and_b32 v149, 0xffff0000, v129
    v_lshlrev_b32 v150, 16, v133
    v_and_b32 v151, 0xffff0000, v133
    v_lshlrev_b32 v152, 16, v130
    v_and_b32 v153, 0xffff0000, v130
    v_lshlrev_b32 v154, 16, v134
    v_and_b32 v155, 0xffff0000, v134
    v_lshlrev_b32 v156, 16, v131
    v_and_b32 v157, 0xffff0000, v131
    v_lshlrev_b32 v158, 16, v135
    v_and_b32 v159, 0xffff0000, v135
    v_pk_add_f32 v[144:145], v[144:145], v[146:147] neg_lo:[0,1] neg_hi:[0,1]
    v_pk_add_f32 v[148:149], v[148:149], v[150:151] neg_lo:[0,1] neg_hi:[0,1]
    v_pk_add_f32 v[152:153], v[152:153], v[154:155] neg_lo:[0,1] neg_hi:[0,1]
    v_pk_add_f32 v[156:157], v[156:157], v[158:159] neg_lo:[0,1] neg_hi:[0,1]
    v_cvt_pk_bf16_f32 v164, v144, v145
    v_cvt_pk_bf16_f32 v165, v148, v149
    v_cvt_pk_bf16_f32 v166, v152, v153
    v_cvt_pk_bf16_f32 v167, v156, v157
    s_add_u32 s51, s74, 110592
    buffer_store_dwordx4 v[164:167], v6, s[40:43], s51 offen sc1
    s_waitcnt vmcnt(21)
    s_barrier
    s_add_u32 m0, s55, 35584
    s_add_u32 s51, s57, 4046848
    buffer_load_dwordx4 v1, s[24:27], s51 offen lds
    s_add_u32 m0, s55, 39680
    s_add_u32 s51, s57, 229376
    buffer_load_dwordx4 v1, s[24:27], s51 offen lds
    s_add_u32 m0, s55, 43776
    s_add_u32 s51, s57, 753664
    buffer_load_dwordx4 v1, s[24:27], s51 offen lds
    s_add_u32 m0, s55, 47872
    s_add_u32 s51, s57, 1277952
    buffer_load_dwordx4 v1, s[24:27], s51 offen lds
    s_add_u32 m0, s55, 51968
    s_add_u32 s51, s57, 1802240
    buffer_load_dwordx4 v1, s[24:27], s51 offen lds
    s_add_u32 m0, s55, 56064
    s_add_u32 s51, s57, 2326528
    buffer_load_dwordx4 v1, s[24:27], s51 offen lds
    s_add_u32 m0, s55, 60160
    s_add_u32 s51, s57, 2850816
    buffer_load_dwordx4 v1, s[24:27], s51 offen lds
    s_add_u32 m0, s55, 64256
    s_add_u32 s51, s57, 3375104
    buffer_load_dwordx4 v1, s[24:27], s51 offen lds
    s_cmp_lg_u32 s69, 2
    s_cbranch_scc1 L_hf2
    s_waitcnt vmcnt(29)
    v_lshlrev_b32 v144, 16, v136
    v_and_b32 v145, 0xffff0000, v136
    v_lshlrev_b32 v146, 16, v140
    v_and_b32 v147, 0xffff0000, v140
    v_lshlrev_b32 v148, 16, v137
    v_and_b32 v149, 0xffff0000, v137
    v_lshlrev_b32 v150, 16, v141
    v_and_b32 v151, 0xffff0000, v141
    v_lshlrev_b32 v152, 16, v138
    v_and_b32 v153, 0xffff0000, v138
    v_lshlrev_b32 v154, 16, v142
    v_and_b32 v155, 0xffff0000, v142
    v_lshlrev_b32 v156, 16, v139
    v_and_b32 v157, 0xffff0000, v139
    v_lshlrev_b32 v158, 16, v143
    v_and_b32 v159, 0xffff0000, v143
    v_pk_add_f32 v[144:145], v[144:145], v[146:147] neg_lo:[0,1] neg_hi:[0,1]
    v_pk_add_f32 v[148:149], v[148:149], v[150:151] neg_lo:[0,1] neg_hi:[0,1]
    v_pk_add_f32 v[152:153], v[152:153], v[154:155] neg_lo:[0,1] neg_hi:[0,1]
    v_pk_add_f32 v[156:157], v[156:157], v[158:159] neg_lo:[0,1] neg_hi:[0,1]
    v_cvt_pk_bf16_f32 v168, v144, v145
    v_cvt_pk_bf16_f32 v169, v148, v149
    v_cvt_pk_bf16_f32 v170, v152, v153
    v_cvt_pk_bf16_f32 v171, v156, v157
    s_add_u32 s51, s61, 45056
    buffer_store_dwordx4 v[168:171], v5, s[40:43], s51 offen sc1
L_hf2:
    s_waitcnt vmcnt(16)
    s_barrier
    s_add_u32 s51, s73, 384
    buffer_load_dwordx4 v[120:123], v2, s[20:23], s51 offen offset:1024
    buffer_load_dwordx4 v[124:127], v2, s[20:23], s51 offen offset:2048
    s_add_u32 m0, s56, 0
    s_add_u32 s51, s58, 896
    buffer_load_dwordx4 v2, s[20:23], s51 offen lds
    s_add_u32 m0, s56, 4224
    s_add_u32 s51, s58, 66432
    buffer_load_dwordx4 v2, s[20:23], s51 offen lds
    s_add_u32 m0, s56, 8448
    s_add_u32 s51, s58, 131968
    buffer_load_dwordx4 v2, s[20:23], s51 offen lds
    s_add_u32 m0, s56, 12672
    s_add_u32 s51, s58, 197504
    buffer_load_dwordx4 v2, s[20:23], s51 offen lds
    s_mov_b32 m0, 16896
    s_add_u32 s51, s49, 263040
    s_mov_b32 exec_hi, 0xffffff
    buffer_load_dwordx4 v2, s[20:23], s51 offen lds
    s_mov_b32 exec_hi, -1
    s_add_u32 m0, s55, 68352
    s_add_u32 s51, s57, 3899392
    buffer_load_dwordx4 v1, s[24:27], s51 offen lds
    s_add_u32 m0, s55, 72448
    s_add_u32 s51, s57, 245760
    buffer_load_dwordx4 v1, s[24:27], s51 offen lds
    s_add_u32 m0, s55, 76544
    s_add_u32 s51, s57, 770048
    buffer_load_dwordx4 v1, s[24:27], s51 offen lds
    s_add_u32 m0, s55, 80640
    s_add_u32 s51, s57, 1294336
    buffer_load_dwordx4 v1, s[24:27], s51 offen lds
    s_add_u32 m0, s55, 84736
    s_add_u32 s51, s57, 1818624
    buffer_load_dwordx4 v1, s[24:27], s51 offen lds
    s_add_u32 m0, s55, 88832
    s_add_u32 s51, s57, 2342912
    buffer_load_dwordx4 v1, s[24:27], s51 offen lds
    s_add_u32 m0, s55, 92928
    s_add_u32 s51, s57, 2867200
    buffer_load_dwordx4 v1, s[24:27], s51 offen lds
    s_add_u32 m0, s55, 97024
    s_add_u32 s51, s57, 3391488
    buffer_load_dwordx4 v1, s[24:27], s51 offen lds
    s_waitcnt vmcnt(22)
    s_barrier
    s_add_u32 m0, s55, 101120
    s_add_u32 s51, s57, 3915776
    buffer_load_dwordx4 v1, s[24:27], s51 offen lds
    s_add_u32 m0, s55, 105216
    s_add_u32 s51, s57, 491520
    buffer_load_dwordx4 v1, s[24:27], s51 offen lds
    s_add_u32 m0, s55, 109312
    s_add_u32 s51, s57, 1015808
    buffer_load_dwordx4 v1, s[24:27], s51 offen lds
    s_add_u32 m0, s55, 113408
    s_add_u32 s51, s57, 1540096
    buffer_load_dwordx4 v1, s[24:27], s51 offen lds
    s_add_u32 m0, s55, 117504
    s_add_u32 s51, s57, 2064384
    buffer_load_dwordx4 v1, s[24:27], s51 offen lds
    s_add_u32 m0, s55, 121600
    s_add_u32 s51, s57, 2588672
    buffer_load_dwordx4 v1, s[24:27], s51 offen lds
    s_add_u32 m0, s55, 125696
    s_add_u32 s51, s57, 3112960
    buffer_load_dwordx4 v1, s[24:27], s51 offen lds
    s_add_u32 m0, s55, 129792
    s_add_u32 s51, s57, 3637248
    buffer_load_dwordx4 v1, s[24:27], s51 offen lds
    s_waitcnt vmcnt(23)
    s_waitcnt vmcnt(15)
    s_barrier
    global_load_dword v21, v7, s[14:15] sc1
    s_add_u32 m0, s56, 17792
    s_add_u32 s51, s58, 1920
    buffer_load_dwordx4 v2, s[20:23], s51 offen lds
    s_add_u32 m0, s56, 22016
    s_add_u32 s51, s58, 67456
    buffer_load_dwordx4 v2, s[20:23], s51 offen lds
    s_add_u32 m0, s56, 26240
    s_add_u32 s51, s58, 132992
    buffer_load_dwordx4 v2, s[20:23], s51 offen lds
    s_add_u32 m0, s56, 30464
    s_add_u32 s51, s58, 198528
    buffer_load_dwordx4 v2, s[20:23], s51 offen lds
    s_mov_b32 m0, 34688
    s_add_u32 s51, s49, 264064
    s_mov_b32 exec_hi, 0xffffff
    buffer_load_dwordx4 v2, s[20:23], s51 offen lds
    s_mov_b32 exec_hi, -1
    s_add_u32 m0, s55, 133888
    s_add_u32 s51, s57, 507904
    buffer_load_dwordx4 v1, s[24:27], s51 offen lds
    s_add_u32 m0, s55, 137984
    s_add_u32 s51, s57, 1032192
    buffer_load_dwordx4 v1, s[24:27], s51 offen lds
    s_add_u32 m0, s55, 142080
    s_add_u32 s51, s57, 1556480
    buffer_load_dwordx4 v1, s[24:27], s51 offen lds
    s_add_u32 m0, s55, 146176
    s_add_u32 s51, s57, 2080768
    buffer_load_dwordx4 v1, s[24:27], s51 offen lds
    s_add_u32 m0, s55, 150272
    s_add_u32 s51, s57, 2605056
    buffer_load_dwordx4 v1, s[24:27], s51 offen lds
    s_add_u32 m0, s55, 154368
    s_add_u32 s51, s57, 3129344
    buffer_load_dwordx4 v1, s[24:27], s51 offen lds
    s_add_u32 m0, s55, 158464
    s_add_u32 s51, s57, 3653632
    buffer_load_dwordx4 v1, s[24:27], s51 offen lds
    s_waitcnt vmcnt(63)
    v_lshlrev_b32 v144, 16, v120
    v_and_b32 v145, 0xffff0000, v120
    v_lshlrev_b32 v146, 16, v124
    v_and_b32 v147, 0xffff0000, v124
    v_lshlrev_b32 v148, 16, v121
    v_and_b32 v149, 0xffff0000, v121
    v_lshlrev_b32 v150, 16, v125
    v_and_b32 v151, 0xffff0000, v125
    v_lshlrev_b32 v152, 16, v122
    v_and_b32 v153, 0xffff0000, v122
    v_lshlrev_b32 v154, 16, v126
    v_and_b32 v155, 0xffff0000, v126
    v_lshlrev_b32 v156, 16, v123
    v_and_b32 v157, 0xffff0000, v123
    v_lshlrev_b32 v158, 16, v127
    v_and_b32 v159, 0xffff0000, v127
    v_pk_add_f32 v[144:145], v[144:145], v[146:147] neg_lo:[0,1] neg_hi:[0,1]
    v_pk_add_f32 v[148:149], v[148:149], v[150:151] neg_lo:[0,1] neg_hi:[0,1]
    v_pk_add_f32 v[152:153], v[152:153], v[154:155] neg_lo:[0,1] neg_hi:[0,1]
    v_pk_add_f32 v[156:157], v[156:157], v[158:159] neg_lo:[0,1] neg_hi:[0,1]
    v_cvt_pk_bf16_f32 v160, v144, v145
    v_cvt_pk_bf16_f32 v161, v148, v149
    v_cvt_pk_bf16_f32 v162, v152, v153
    v_cvt_pk_bf16_f32 v163, v156, v157
    s_add_u32 s51, s74, 55296
    buffer_store_dwordx4 v[160:163], v6, s[40:43], s51 offen sc1
    s_waitcnt vmcnt(21)
    s_barrier
    s_waitcnt vmcnt(13)
    s_mov_b32 s70, 0
    s_branch L_gpoll_c
L_gpoll:
    global_load_dword v21, v7, s[14:15] sc1
    s_waitcnt vmcnt(0)
L_gpoll_c:
    s_add_u32 s70, s70, 1
    v_readfirstlane_b32 s51, v21
    s_cmp_ge_u32 s70, 0x200000
    s_cbranch_scc1 L_gpoll_d
    s_cmp_lt_u32 s51, 256
    s_cbranch_scc1 L_gpoll
L_gpoll_d:
    s_add_u32 m0, s55, 35584
    s_add_u32 s51, s66, 0
    buffer_load_dwordx4 v1, s[36:39], s51 offen sc1 lds
    s_add_u32 m0, s55, 39680
    s_add_u32 s51, s66, 131072
    buffer_load_dwordx4 v1, s[36:39], s51 offen sc1 lds
    s_add_u32 m0, s55, 43776
    s_add_u32 s51, s66, 262144
    buffer_load_dwordx4 v1, s[36:39], s51 offen sc1 lds
    s_add_u32 m0, s55, 47872
    s_add_u32 s51, s66, 393216
    buffer_load_dwordx4 v1, s[36:39], s51 offen sc1 lds
    s_add_u32 m0, s55, 51968
    s_add_u32 s51, s66, 524288
    buffer_load_dwordx4 v1, s[36:39], s51 offen sc1 lds
    s_add_u32 m0, s55, 56064
    s_add_u32 s51, s66, 655360
    buffer_load_dwordx4 v1, s[36:39], s51 offen sc1 lds
    s_add_u32 m0, s55, 60160
    s_add_u32 s51, s66, 786432
    buffer_load_dwordx4 v1, s[36:39], s51 offen sc1 lds
    s_add_u32 m0, s55, 64256
    s_add_u32 s51, s66, 917504
    buffer_load_dwordx4 v1, s[36:39], s51 offen sc1 lds
    s_waitcnt vmcnt(16)
    s_barrier
    s_add_u32 s51, s73, 896
    buffer_load_dwordx4 v[128:131], v2, s[20:23], s51 offen offset:1024
    buffer_load_dwordx4 v[132:135], v2, s[20:23], s51 offen offset:2048
    s_add_u32 s52, s71, s68
    s_add_u32 m0, s52, 0
    s_add_u32 s51, s59, 0
    buffer_load_dwordx4 v3, s[40:43], s51 offen sc1 lds
    s_add_u32 m0, s52, 4352
    s_add_u32 s51, s59, 4096
    buffer_load_dwordx4 v3, s[40:43], s51 offen sc1 lds
    s_add_u32 m0, s68, 8704
    s_add_u32 s51, s67, 8192
    s_mov_b64 exec, 0xfffffff
    buffer_load_dwordx4 v3, s[40:43], s51 offen sc1 lds
    s_mov_b64 exec, -1
    s_add_u32 s68, s68, 9152
    s_cmp_ge_u32 s68, 27456
    s_cselect_b32 s68, 0, s68
    s_add_u32 m0, s55, 68352
    s_add_u32 s51, s66, 1048576
    buffer_load_dwordx4 v1, s[36:39], s51 offen sc1 lds
    s_add_u32 m0, s55, 72448
    s_add_u32 s51, s66, 1179648
    buffer_load_dwordx4 v1, s[36:39], s51 offen sc1 lds
    s_add_u32 m0, s55, 76544
    s_add_u32 s51, s66, 1310720
    buffer_load_dwordx4 v1, s[36:39], s51 offen sc1 lds
    s_add_u32 m0, s55, 80640
    s_add_u32 s51, s66, 1441792
    buffer_load_dwordx4 v1, s[36:39], s51 offen sc1 lds
    s_add_u32 m0, s55, 84736
    s_add_u32 s51, s66, 1572864
    buffer_load_dwordx4 v1, s[36:39], s51 offen sc1 lds
    s_add_u32 m0, s55, 88832
    s_add_u32 s51, s66, 1703936
    buffer_load_dwordx4 v1, s[36:39], s51 offen sc1 lds
    s_add_u32 m0, s55, 92928
    s_add_u32 s51, s66, 1835008
    buffer_load_dwordx4 v1, s[36:39], s51 offen sc1 lds
    s_add_u32 m0, s55, 97024
    s_add_u32 s51, s66, 1966080
    buffer_load_dwordx4 v1, s[36:39], s51 offen sc1 lds
    s_waitcnt vmcnt(22)
    s_barrier
    s_cmp_lg_u32 s69, 3
    s_cbranch_scc1 L_hl3
    s_add_u32 s51, s60, 262528
    buffer_load_dwordx4 v[136:139], v2, s[20:23], s51 offen offset:1024
    buffer_load_dwordx4 v[140:143], v2, s[20:23], s51 offen offset:2048
L_hl3:
    s_add_u32 s52, s71, s68
    s_add_u32 m0, s52, 0
    s_add_u32 s51, s59, 73728
    buffer_load_dwordx4 v3, s[40:43], s51 offen sc1 lds
    s_add_u32 m0, s52, 4352
    s_add_u32 s51, s59, 77824
    buffer_load_dwordx4 v3, s[40:43], s51 offen sc1 lds
    s_add_u32 m0, s55, 101120
    s_add_u32 s51, s66, 16384
    buffer_load_dwordx4 v1, s[36:39], s51 offen sc1 lds
    s_add_u32 m0, s55, 105216
    s_add_u32 s51, s66, 147456
    buffer_load_dwordx4 v1, s[36:39], s51 offen sc1 lds
    s_add_u32 m0, s55, 109312
    s_add_u32 s51, s66, 278528
    buffer_load_dwordx4 v1, s[36:39], s51 offen sc1 lds
    s_add_u32 m0, s55, 113408
    s_add_u32 s51, s66, 409600
    buffer_load_dwordx4 v1, s[36:39], s51 offen sc1 lds
    s_add_u32 m0, s55, 117504
    s_add_u32 s51, s66, 540672
    buffer_load_dwordx4 v1, s[36:39], s51 offen sc1 lds
    s_add_u32 m0, s55, 121600
    s_add_u32 s51, s66, 671744
    buffer_load_dwordx4 v1, s[36:39], s51 offen sc1 lds
    s_add_u32 m0, s55, 125696
    s_add_u32 s51, s66, 802816
    buffer_load_dwordx4 v1, s[36:39], s51 offen sc1 lds
    s_add_u32 m0, s55, 129792
    s_add_u32 s51, s66, 933888
    buffer_load_dwordx4 v1, s[36:39], s51 offen sc1 lds
    s_waitcnt vmcnt(18)
    s_barrier
    s_add_u32 m0, s68, 8704
    s_add_u32 s51, s67, 81920
    s_mov_b64 exec, 0xfffffff
    buffer_load_dwordx4 v3, s[40:43], s51 offen sc1 lds
    s_mov_b64 exec, -1
    s_add_u32 s68, s68, 9152
    s_cmp_ge_u32 s68, 27456
    s_cselect_b32 s68, 0, s68
    s_add_u32 s52, s71, s68
    s_add_u32 m0, s52, 0
    s_add_u32 s51, s59, 9216
    buffer_load_dwordx4 v3, s[40:43], s51 offen sc1 lds
    s_add_u32 m0, s52, 4352
    s_add_u32 s51, s59, 13312
    buffer_load_dwordx4 v3, s[40:43], s51 offen sc1 lds
    s_add_u32 m0, s68, 8704
    s_add_u32 s51, s67, 17408
    s_mov_b64 exec, 0xfffffff
    buffer_load_dwordx4 v3, s[40:43], s51 offen sc1 lds
    s_mov_b64 exec, -1
    s_add_u32 s68, s68, 9152
    s_cmp_ge_u32 s68, 27456
    s_cselect_b32 s68, 0, s68
    s_add_u32 m0, s55, 133888
    s_add_u32 s51, s66, 1064960
    buffer_load_dwordx4 v1, s[36:39], s51 offen sc1 lds
    s_add_u32 m0, s55, 137984
    s_add_u32 s51, s66, 1196032
    buffer_load_dwordx4 v1, s[36:39], s51 offen sc1 lds
    s_add_u32 m0, s55, 142080
    s_add_u32 s51, s66, 1327104
    buffer_load_dwordx4 v1, s[36:39], s51 offen sc1 lds
    s_add_u32 m0, s55, 146176
    s_add_u32 s51, s66, 1458176
    buffer_load_dwordx4 v1, s[36:39], s51 offen sc1 lds
    s_add_u32 m0, s55, 150272
    s_add_u32 s51, s66, 1589248
    buffer_load_dwordx4 v1, s[36:39], s51 offen sc1 lds
    s_add_u32 m0, s55, 154368
    s_add_u32 s51, s66, 1720320
    buffer_load_dwordx4 v1, s[36:39], s51 offen sc1 lds
    s_add_u32 m0, s55, 158464
    s_add_u32 s51, s66, 1851392
    buffer_load_dwordx4 v1, s[36:39], s51 offen sc1 lds
    s_add_u32 m0, s55, 27456
    s_add_u32 s51, s66, 1982464
    buffer_load_dwordx4 v1, s[36:39], s51 offen sc1 lds
    s_waitcnt vmcnt(63)
    v_lshlrev_b32 v144, 16, v128
    v_and_b32 v145, 0xffff0000, v128
    v_lshlrev_b32 v146, 16, v132
    v_and_b32 v147, 0xffff0000, v132
    v_lshlrev_b32 v148, 16, v129
    v_and_b32 v149, 0xffff0000, v129
    v_lshlrev_b32 v150, 16, v133
    v_and_b32 v151, 0xffff0000, v133
    v_lshlrev_b32 v152, 16, v130
    v_and_b32 v153, 0xffff0000, v130
    v_lshlrev_b32 v154, 16, v134
    v_and_b32 v155, 0xffff0000, v134
    v_lshlrev_b32 v156, 16, v131
    v_and_b32 v157, 0xffff0000, v131
    v_lshlrev_b32 v158, 16, v135
    v_and_b32 v159, 0xffff0000, v135
    v_pk_add_f32 v[144:145], v[144:145], v[146:147] neg_lo:[0,1] neg_hi:[0,1]
    v_pk_add_f32 v[148:149], v[148:149], v[150:151] neg_lo:[0,1] neg_hi:[0,1]
    v_pk_add_f32 v[152:153], v[152:153], v[154:155] neg_lo:[0,1] neg_hi:[0,1]
    v_pk_add_f32 v[156:157], v[156:157], v[158:159] neg_lo:[0,1] neg_hi:[0,1]
    v_cvt_pk_bf16_f32 v164, v144, v145
    v_cvt_pk_bf16_f32 v165, v148, v149
    v_cvt_pk_bf16_f32 v166, v152, v153
    v_cvt_pk_bf16_f32 v167, v156, v157
    s_add_u32 s51, s74, 129024
    buffer_store_dwordx4 v[164:167], v6, s[40:43], s51 offen sc1
    s_waitcnt vmcnt(12)
    s_barrier
    buffer_load_dwordx4 v[24:27], v7, s[32:35], s54 offen offset:16 sc1
    s_add_u32 s52, s71, s68
    s_add_u32 m0, s52, 0
    s_add_u32 s51, s59, 82944
    buffer_load_dwordx4 v3, s[40:43], s51 offen sc1 lds
    s_add_u32 m0, s52, 4352
    s_add_u32 s51, s59, 87040
    buffer_load_dwordx4 v3, s[40:43], s51 offen sc1 lds
    s_add_u32 m0, s68, 8704
    s_add_u32 s51, s67, 91136
    s_mov_b64 exec, 0xfffffff
    buffer_load_dwordx4 v3, s[40:43], s51 offen sc1 lds
    s_mov_b64 exec, -1
    s_add_u32 s68, s68, 9152
    s_cmp_ge_u32 s68, 27456
    s_cselect_b32 s68, 0, s68
    s_add_u32 m0, s55, 35584
    s_add_u32 s51, s66, 32768
    buffer_load_dwordx4 v1, s[36:39], s51 offen sc1 lds
    s_add_u32 m0, s55, 39680
    s_add_u32 s51, s66, 163840
    buffer_load_dwordx4 v1, s[36:39], s51 offen sc1 lds
    s_add_u32 m0, s55, 43776
    s_add_u32 s51, s66, 294912
    buffer_load_dwordx4 v1, s[36:39], s51 offen sc1 lds
    s_add_u32 m0, s55, 47872
    s_add_u32 s51, s66, 425984
    buffer_load_dwordx4 v1, s[36:39], s51 offen sc1 lds
    s_add_u32 m0, s55, 51968
    s_add_u32 s51, s66, 557056
    buffer_load_dwordx4 v1, s[36:39], s51 offen sc1 lds
    s_add_u32 m0, s55, 56064
    s_add_u32 s51, s66, 688128
    buffer_load_dwordx4 v1, s[36:39], s51 offen sc1 lds
    s_add_u32 m0, s55, 60160
    s_add_u32 s51, s66, 819200
    buffer_load_dwordx4 v1, s[36:39], s51 offen sc1 lds
    s_add_u32 m0, s55, 64256
    s_add_u32 s51, s66, 950272
    buffer_load_dwordx4 v1, s[36:39], s51 offen sc1 lds
    s_cmp_lg_u32 s69, 3
    s_cbranch_scc1 L_hf3
    s_waitcnt vmcnt(63)
    v_lshlrev_b32 v144, 16, v136
    v_and_b32 v145, 0xffff0000, v136
    v_lshlrev_b32 v146, 16, v140
    v_and_b32 v147, 0xffff0000, v140
    v_lshlrev_b32 v148, 16, v137
    v_and_b32 v149, 0xffff0000, v137
    v_lshlrev_b32 v150, 16, v141
    v_and_b32 v151, 0xffff0000, v141
    v_lshlrev_b32 v152, 16, v138
    v_and_b32 v153, 0xffff0000, v138
    v_lshlrev_b32 v154, 16, v142
    v_and_b32 v155, 0xffff0000, v142
    v_lshlrev_b32 v156, 16, v139
    v_and_b32 v157, 0xffff0000, v139
    v_lshlrev_b32 v158, 16, v143
    v_and_b32 v159, 0xffff0000, v143
    v_pk_add_f32 v[144:145], v[144:145], v[146:147] neg_lo:[0,1] neg_hi:[0,1]
    v_pk_add_f32 v[148:149], v[148:149], v[150:151] neg_lo:[0,1] neg_hi:[0,1]
    v_pk_add_f32 v[152:153], v[152:153], v[154:155] neg_lo:[0,1] neg_hi:[0,1]
    v_pk_add_f32 v[156:157], v[156:157], v[158:159] neg_lo:[0,1] neg_hi:[0,1]
    v_cvt_pk_bf16_f32 v168, v144, v145
    v_cvt_pk_bf16_f32 v169, v148, v149
    v_cvt_pk_bf16_f32 v170, v152, v153
    v_cvt_pk_bf16_f32 v171, v156, v157
    s_add_u32 s51, s61, 63488
    buffer_store_dwordx4 v[168:171], v5, s[40:43], s51 offen sc1
L_hf3:
    s_waitcnt vmcnt(21)
    s_barrier
    s_waitcnt vmcnt(11)
    s_mov_b32 s70, 0
    s_branch L_fpoll1_c
L_fpoll1:
    buffer_load_dwordx4 v[24:27], v7, s[32:35], s54 offen offset:16 sc1
    s_waitcnt vmcnt(0)
L_fpoll1_c:
    v_and_b32 v21, v24, v25
    v_and_b32 v22, v26, v27
    v_and_b32 v21, v21, v22
    s_add_u32 s70, s70, 1
    v_readfirstlane_b32 s51, v21
    s_cmp_ge_u32 s70, 0x200000
    s_cbranch_scc1 L_fpoll1_d
    s_cmp_lt_u32 s51, 1
    s_cbranch_scc1 L_fpoll1
L_fpoll1_d:
    s_add_u32 s52, s71, s68
    s_add_u32 m0, s52, 0
    s_add_u32 s51, s59, 18432
    buffer_load_dwordx4 v3, s[40:43], s51 offen sc1 lds
    s_add_u32 m0, s52, 4352
    s_add_u32 s51, s59, 22528
    buffer_load_dwordx4 v3, s[40:43], s51 offen sc1 lds
    s_add_u32 m0, s68, 8704
    s_add_u32 s51, s67, 26624
    s_mov_b64 exec, 0xfffffff
    buffer_load_dwordx4 v3, s[40:43], s51 offen sc1 lds
    s_mov_b64 exec, -1
    s_add_u32 s68, s68, 9152
    s_cmp_ge_u32 s68, 27456
    s_cselect_b32 s68, 0, s68
    s_add_u32 m0, s55, 68352
    s_add_u32 s51, s66, 1081344
    buffer_load_dwordx4 v1, s[36:39], s51 offen sc1 lds
    s_add_u32 m0, s55, 72448
    s_add_u32 s51, s66, 1212416
    buffer_load_dwordx4 v1, s[36:39], s51 offen sc1 lds
    s_add_u32 m0, s55, 76544
    s_add_u32 s51, s66, 1343488
    buffer_load_dwordx4 v1, s[36:39], s51 offen sc1 lds
    s_add_u32 m0, s55, 80640
    s_add_u32 s51, s66, 1474560
    buffer_load_dwordx4 v1, s[36:39], s51 offen sc1 lds
    s_add_u32 m0, s55, 84736
    s_add_u32 s51, s66, 1605632
    buffer_load_dwordx4 v1, s[36:39], s51 offen sc1 lds
    s_add_u32 m0, s55, 88832
    s_add_u32 s51, s66, 1736704
    buffer_load_dwordx4 v1, s[36:39], s51 offen sc1 lds
    s_add_u32 m0, s55, 92928
    s_add_u32 s51, s66, 1867776
    buffer_load_dwordx4 v1, s[36:39], s51 offen sc1 lds
    s_add_u32 m0, s55, 97024
    s_add_u32 s51, s66, 1998848
    buffer_load_dwordx4 v1, s[36:39], s51 offen sc1 lds
    s_waitcnt vmcnt(19)
    s_barrier
    s_add_u32 s52, s71, s68
    s_add_u32 m0, s52, 0
    s_add_u32 s51, s59, 92160
    buffer_load_dwordx4 v3, s[40:43], s51 offen sc1 lds
    s_add_u32 m0, s52, 4352
    s_add_u32 s51, s59, 96256
    buffer_load_dwordx4 v3, s[40:43], s51 offen sc1 lds
    s_add_u32 m0, s68, 8704
    s_add_u32 s51, s67, 100352
    s_mov_b64 exec, 0xfffffff
    buffer_load_dwordx4 v3, s[40:43], s51 offen sc1 lds
    s_mov_b64 exec, -1
    s_add_u32 s68, s68, 9152
    s_cmp_ge_u32 s68, 27456
    s_cselect_b32 s68, 0, s68
    s_add_u32 m0, s55, 101120
    s_add_u32 s51, s66, 49152
    buffer_load_dwordx4 v1, s[36:39], s51 offen sc1 lds
    s_add_u32 m0, s55, 105216
    s_add_u32 s51, s66, 180224
    buffer_load_dwordx4 v1, s[36:39], s51 offen sc1 lds
    s_add_u32 m0, s55, 109312
    s_add_u32 s51, s66, 311296
    buffer_load_dwordx4 v1, s[36:39], s51 offen sc1 lds
    s_add_u32 m0, s55, 113408
    s_add_u32 s51, s66, 442368
    buffer_load_dwordx4 v1, s[36:39], s51 offen sc1 lds
    s_add_u32 m0, s55, 117504
    s_add_u32 s51, s66, 573440
    buffer_load_dwordx4 v1, s[36:39], s51 offen sc1 lds
    s_add_u32 m0, s55, 121600
    s_add_u32 s51, s66, 704512
    buffer_load_dwordx4 v1, s[36:39], s51 offen sc1 lds
    s_add_u32 m0, s55, 125696
    s_add_u32 s51, s66, 835584
    buffer_load_dwordx4 v1, s[36:39], s51 offen sc1 lds
    s_add_u32 m0, s55, 129792
    s_add_u32 s51, s66, 966656
    buffer_load_dwordx4 v1, s[36:39], s51 offen sc1 lds
    s_waitcnt vmcnt(22)
    s_waitcnt vmcnt(19)
    s_barrier
    s_add_u32 s52, s71, s68
    s_add_u32 m0, s52, 0
    s_add_u32 s51, s59, 27648
    buffer_load_dwordx4 v3, s[40:43], s51 offen sc1 lds
    s_add_u32 m0, s52, 4352
    s_add_u32 s51, s59, 31744
    buffer_load_dwordx4 v3, s[40:43], s51 offen sc1 lds
    s_add_u32 m0, s68, 8704
    s_add_u32 s51, s67, 35840
    s_mov_b64 exec, 0xfffffff
    buffer_load_dwordx4 v3, s[40:43], s51 offen sc1 lds
    s_mov_b64 exec, -1
    s_add_u32 s68, s68, 9152
    s_cmp_ge_u32 s68, 27456
    s_cselect_b32 s68, 0, s68
    s_add_u32 m0, s55, 133888
    s_add_u32 s51, s66, 1097728
    buffer_load_dwordx4 v1, s[36:39], s51 offen sc1 lds
    s_add_u32 m0, s55, 137984
    s_add_u32 s51, s66, 1228800
    buffer_load_dwordx4 v1, s[36:39], s51 offen sc1 lds
    s_add_u32 m0, s55, 142080
    s_add_u32 s51, s66, 1359872
    buffer_load_dwordx4 v1, s[36:39], s51 offen sc1 lds
    s_add_u32 m0, s55, 146176
    s_add_u32 s51, s66, 1490944
    buffer_load_dwordx4 v1, s[36:39], s51 offen sc1 lds
    s_add_u32 m0, s55, 150272
    s_add_u32 s51, s66, 1622016
    buffer_load_dwordx4 v1, s[36:39], s51 offen sc1 lds
    s_add_u32 m0, s55, 154368
    s_add_u32 s51, s66, 1753088
    buffer_load_dwordx4 v1, s[36:39], s51 offen sc1 lds
    s_add_u32 m0, s55, 158464
    s_add_u32 s51, s66, 1884160
    buffer_load_dwordx4 v1, s[36:39], s51 offen sc1 lds
    s_add_u32 m0, s55, 27456
    s_add_u32 s51, s66, 2015232
    buffer_load_dwordx4 v1, s[36:39], s51 offen sc1 lds
    s_waitcnt vmcnt(19)
    s_barrier
    buffer_load_dwordx4 v[24:27], v7, s[32:35], s54 offen offset:32 sc1
    s_add_u32 s52, s71, s68
    s_add_u32 m0, s52, 0
    s_add_u32 s51, s59, 101376
    buffer_load_dwordx4 v3, s[40:43], s51 offen sc1 lds
    s_add_u32 m0, s52, 4352
    s_add_u32 s51, s59, 105472
    buffer_load_dwordx4 v3, s[40:43], s51 offen sc1 lds
    s_add_u32 m0, s68, 8704
    s_add_u32 s51, s67, 109568
    s_mov_b64 exec, 0xfffffff
    buffer_load_dwordx4 v3, s[40:43], s51 offen sc1 lds
    s_mov_b64 exec, -1
    s_add_u32 s68, s68, 9152
    s_cmp_ge_u32 s68, 27456
    s_cselect_b32 s68, 0, s68
    s_add_u32 m0, s55, 35584
    s_add_u32 s51, s66, 65536
    buffer_load_dwordx4 v1, s[36:39], s51 offen sc1 lds
    s_add_u32 m0, s55, 39680
    s_add_u32 s51, s66, 196608
    buffer_load_dwordx4 v1, s[36:39], s51 offen sc1 lds
    s_add_u32 m0, s55, 43776
    s_add_u32 s51, s66, 327680
    buffer_load_dwordx4 v1, s[36:39], s51 offen sc1 lds
    s_add_u32 m0, s55, 47872
    s_add_u32 s51, s66, 458752
    buffer_load_dwordx4 v1, s[36:39], s51 offen sc1 lds
    s_add_u32 m0, s55, 51968
    s_add_u32 s51, s66, 589824
    buffer_load_dwordx4 v1, s[36:39], s51 offen sc1 lds
    s_add_u32 m0, s55, 56064
    s_add_u32 s51, s66, 720896
    buffer_load_dwordx4 v1, s[36:39], s51 offen sc1 lds
    s_add_u32 m0, s55, 60160
    s_add_u32 s51, s66, 851968
    buffer_load_dwordx4 v1, s[36:39], s51 offen sc1 lds
    s_add_u32 m0, s55, 64256
    s_add_u32 s51, s66, 983040
    buffer_load_dwordx4 v1, s[36:39], s51 offen sc1 lds
    s_waitcnt vmcnt(20)
    s_barrier
    s_waitcnt vmcnt(11)
    s_mov_b32 s70, 0
    s_branch L_fpoll2_c
L_fpoll2:
    buffer_load_dwordx4 v[24:27], v7, s[32:35], s54 offen offset:32 sc1
    s_waitcnt vmcnt(0)
L_fpoll2_c:
    v_and_b32 v21, v24, v25
    v_and_b32 v22, v26, v27
    v_and_b32 v21, v21, v22
    s_add_u32 s70, s70, 1
    v_readfirstlane_b32 s51, v21
    s_cmp_ge_u32 s70, 0x200000
    s_cbranch_scc1 L_fpoll2_d
    s_cmp_lt_u32 s51, 1
    s_cbranch_scc1 L_fpoll2
L_fpoll2_d:
    s_add_u32 s52, s71, s68
    s_add_u32 m0, s52, 0
    s_add_u32 s51, s59, 36864
    buffer_load_dwordx4 v3, s[40:43], s51 offen sc1 lds
    s_add_u32 m0, s52, 4352
    s_add_u32 s51, s59, 40960
    buffer_load_dwordx4 v3, s[40:43], s51 offen sc1 lds
    s_add_u32 m0, s68, 8704
    s_add_u32 s51, s67, 45056
    s_mov_b64 exec, 0xfffffff
    buffer_load_dwordx4 v3, s[40:43], s51 offen sc1 lds
    s_mov_b64 exec, -1
    s_add_u32 s68, s68, 9152
    s_cmp_ge_u32 s68, 27456
    s_cselect_b32 s68, 0, s68
    s_add_u32 m0, s55, 68352
    s_add_u32 s51, s66, 1114112
    buffer_load_dwordx4 v1, s[36:39], s51 offen sc1 lds
    s_add_u32 m0, s55, 72448
    s_add_u32 s51, s66, 1245184
    buffer_load_dwordx4 v1, s[36:39], s51 offen sc1 lds
    s_add_u32 m0, s55, 76544
    s_add_u32 s51, s66, 1376256
    buffer_load_dwordx4 v1, s[36:39], s51 offen sc1 lds
    s_add_u32 m0, s55, 80640
    s_add_u32 s51, s66, 1507328
    buffer_load_dwordx4 v1, s[36:39], s51 offen sc1 lds
    s_add_u32 m0, s55, 84736
    s_add_u32 s51, s66, 1638400
    buffer_load_dwordx4 v1, s[36:39], s51 offen sc1 lds
    s_add_u32 m0, s55, 88832
    s_add_u32 s51, s66, 1769472
    buffer_load_dwordx4 v1, s[36:39], s51 offen sc1 lds
    s_add_u32 m0, s55, 92928
    s_add_u32 s51, s66, 1900544
    buffer_load_dwordx4 v1, s[36:39], s51 offen sc1 lds
    s_add_u32 m0, s55, 97024
    s_add_u32 s51, s66, 2031616
    buffer_load_dwordx4 v1, s[36:39], s51 offen sc1 lds
    s_waitcnt vmcnt(19)
    s_barrier
    s_add_u32 s52, s71, s68
    s_add_u32 m0, s52, 0
    s_add_u32 s51, s59, 110592
    buffer_load_dwordx4 v3, s[40:43], s51 offen sc1 lds
    s_add_u32 m0, s52, 4352
    s_add_u32 s51, s59, 114688
    buffer_load_dwordx4 v3, s[40:43], s51 offen sc1 lds
    s_add_u32 m0, s68, 8704
    s_add_u32 s51, s67, 118784
    s_mov_b64 exec, 0xfffffff
    buffer_load_dwordx4 v3, s[40:43], s51 offen sc1 lds
    s_mov_b64 exec, -1
    s_add_u32 s68, s68, 9152
    s_cmp_ge_u32 s68, 27456
    s_cselect_b32 s68, 0, s68
    s_add_u32 m0, s55, 101120
    s_add_u32 s51, s66, 81920
    buffer_load_dwordx4 v1, s[36:39], s51 offen sc1 lds
    s_add_u32 m0, s55, 105216
    s_add_u32 s51, s66, 212992
    buffer_load_dwordx4 v1, s[36:39], s51 offen sc1 lds
    s_add_u32 m0, s55, 109312
    s_add_u32 s51, s66, 344064
    buffer_load_dwordx4 v1, s[36:39], s51 offen sc1 lds
    s_add_u32 m0, s55, 113408
    s_add_u32 s51, s66, 475136
    buffer_load_dwordx4 v1, s[36:39], s51 offen sc1 lds
    s_add_u32 m0, s55, 117504
    s_add_u32 s51, s66, 606208
    buffer_load_dwordx4 v1, s[36:39], s51 offen sc1 lds
    s_add_u32 m0, s55, 121600
    s_add_u32 s51, s66, 737280
    buffer_load_dwordx4 v1, s[36:39], s51 offen sc1 lds
    s_add_u32 m0, s55, 125696
    s_add_u32 s51, s66, 868352
    buffer_load_dwordx4 v1, s[36:39], s51 offen sc1 lds
    s_add_u32 m0, s55, 129792
    s_add_u32 s51, s66, 999424
    buffer_load_dwordx4 v1, s[36:39], s51 offen sc1 lds
    s_waitcnt vmcnt(19)
    s_barrier
    s_add_u32 s52, s71, s68
    s_add_u32 m0, s52, 0
    s_add_u32 s51, s59, 46080
    buffer_load_dwordx4 v3, s[40:43], s51 offen sc1 lds
    s_add_u32 m0, s52, 4352
    s_add_u32 s51, s59, 50176
    buffer_load_dwordx4 v3, s[40:43], s51 offen sc1 lds
    s_add_u32 m0, s68, 8704
    s_add_u32 s51, s67, 54272
    s_mov_b64 exec, 0xfffffff
    buffer_load_dwordx4 v3, s[40:43], s51 offen sc1 lds
    s_mov_b64 exec, -1
    s_add_u32 s68, s68, 9152
    s_cmp_ge_u32 s68, 27456
    s_cselect_b32 s68, 0, s68
    s_add_u32 m0, s55, 133888
    s_add_u32 s51, s66, 1130496
    buffer_load_dwordx4 v1, s[36:39], s51 offen sc1 lds
    s_add_u32 m0, s55, 137984
    s_add_u32 s51, s66, 1261568
    buffer_load_dwordx4 v1, s[36:39], s51 offen sc1 lds
    s_add_u32 m0, s55, 142080
    s_add_u32 s51, s66, 1392640
    buffer_load_dwordx4 v1, s[36:39], s51 offen sc1 lds
    s_add_u32 m0, s55, 146176
    s_add_u32 s51, s66, 1523712
    buffer_load_dwordx4 v1, s[36:39], s51 offen sc1 lds
    s_add_u32 m0, s55, 150272
    s_add_u32 s51, s66, 1654784
    buffer_load_dwordx4 v1, s[36:39], s51 offen sc1 lds
    s_add_u32 m0, s55, 154368
    s_add_u32 s51, s66, 1785856
    buffer_load_dwordx4 v1, s[36:39], s51 offen sc1 lds
    s_add_u32 m0, s55, 158464
    s_add_u32 s51, s66, 1916928
    buffer_load_dwordx4 v1, s[36:39], s51 offen sc1 lds
    s_add_u32 m0, s55, 27456
    s_add_u32 s51, s66, 2048000
    buffer_load_dwordx4 v1, s[36:39], s51 offen sc1 lds
    s_waitcnt vmcnt(19)
    s_barrier
    buffer_load_dwordx4 v[24:27], v7, s[32:35], s54 offen offset:48 sc1
    s_add_u32 s52, s71, s68
    s_add_u32 m0, s52, 0
    s_add_u32 s51, s59, 119808
    buffer_load_dwordx4 v3, s[40:43], s51 offen sc1 lds
    s_add_u32 m0, s52, 4352
    s_add_u32 s51, s59, 123904
    buffer_load_dwordx4 v3, s[40:43], s51 offen sc1 lds
    s_add_u32 m0, s68, 8704
    s_add_u32 s51, s67, 128000
    s_mov_b64 exec, 0xfffffff
    buffer_load_dwordx4 v3, s[40:43], s51 offen sc1 lds
    s_mov_b64 exec, -1
    s_add_u32 s68, s68, 9152
    s_cmp_ge_u32 s68, 27456
    s_cselect_b32 s68, 0, s68
    s_add_u32 m0, s55, 35584
    s_add_u32 s51, s66, 98304
    buffer_load_dwordx4 v1, s[36:39], s51 offen sc1 lds
    s_add_u32 m0, s55, 39680
    s_add_u32 s51, s66, 229376
    buffer_load_dwordx4 v1, s[36:39], s51 offen sc1 lds
    s_add_u32 m0, s55, 43776
    s_add_u32 s51, s66, 360448
    buffer_load_dwordx4 v1, s[36:39], s51 offen sc1 lds
    s_add_u32 m0, s55, 47872
    s_add_u32 s51, s66, 491520
    buffer_load_dwordx4 v1, s[36:39], s51 offen sc1 lds
    s_add_u32 m0, s55, 51968
    s_add_u32 s51, s66, 622592
    buffer_load_dwordx4 v1, s[36:39], s51 offen sc1 lds
    s_add_u32 m0, s55, 56064
    s_add_u32 s51, s66, 753664
    buffer_load_dwordx4 v1, s[36:39], s51 offen sc1 lds
    s_add_u32 m0, s55, 60160
    s_add_u32 s51, s66, 884736
    buffer_load_dwordx4 v1, s[36:39], s51 offen sc1 lds
    s_add_u32 m0, s55, 64256
    s_add_u32 s51, s66, 1015808
    buffer_load_dwordx4 v1, s[36:39], s51 offen sc1 lds
    s_waitcnt vmcnt(20)
    s_barrier
    s_waitcnt vmcnt(11)
    s_mov_b32 s70, 0
    s_branch L_fpoll3_c
L_fpoll3:
    buffer_load_dwordx4 v[24:27], v7, s[32:35], s54 offen offset:48 sc1
    s_waitcnt vmcnt(0)
L_fpoll3_c:
    v_and_b32 v21, v24, v25
    v_and_b32 v22, v26, v27
    v_and_b32 v21, v21, v22
    s_add_u32 s70, s70, 1
    v_readfirstlane_b32 s51, v21
    s_cmp_ge_u32 s70, 0x200000
    s_cbranch_scc1 L_fpoll3_d
    s_cmp_lt_u32 s51, 1
    s_cbranch_scc1 L_fpoll3
L_fpoll3_d:
    s_add_u32 s52, s71, s68
    s_add_u32 m0, s52, 0
    s_add_u32 s51, s59, 55296
    buffer_load_dwordx4 v3, s[40:43], s51 offen sc1 lds
    s_add_u32 m0, s52, 4352
    s_add_u32 s51, s59, 59392
    buffer_load_dwordx4 v3, s[40:43], s51 offen sc1 lds
    s_add_u32 m0, s68, 8704
    s_add_u32 s51, s67, 63488
    s_mov_b64 exec, 0xfffffff
    buffer_load_dwordx4 v3, s[40:43], s51 offen sc1 lds
    s_mov_b64 exec, -1
    s_add_u32 s68, s68, 9152
    s_cmp_ge_u32 s68, 27456
    s_cselect_b32 s68, 0, s68
    s_add_u32 m0, s55, 68352
    s_add_u32 s51, s66, 1146880
    buffer_load_dwordx4 v1, s[36:39], s51 offen sc1 lds
    s_add_u32 m0, s55, 72448
    s_add_u32 s51, s66, 1277952
    buffer_load_dwordx4 v1, s[36:39], s51 offen sc1 lds
    s_add_u32 m0, s55, 76544
    s_add_u32 s51, s66, 1409024
    buffer_load_dwordx4 v1, s[36:39], s51 offen sc1 lds
    s_add_u32 m0, s55, 80640
    s_add_u32 s51, s66, 1540096
    buffer_load_dwordx4 v1, s[36:39], s51 offen sc1 lds
    s_add_u32 m0, s55, 84736
    s_add_u32 s51, s66, 1671168
    buffer_load_dwordx4 v1, s[36:39], s51 offen sc1 lds
    s_add_u32 m0, s55, 88832
    s_add_u32 s51, s66, 1802240
    buffer_load_dwordx4 v1, s[36:39], s51 offen sc1 lds
    s_add_u32 m0, s55, 92928
    s_add_u32 s51, s66, 1933312
    buffer_load_dwordx4 v1, s[36:39], s51 offen sc1 lds
    s_add_u32 m0, s55, 97024
    s_add_u32 s51, s66, 2064384
    buffer_load_dwordx4 v1, s[36:39], s51 offen sc1 lds
    s_waitcnt vmcnt(19)
    s_barrier
    s_add_u32 s52, s71, s68
    s_add_u32 m0, s52, 0
    s_add_u32 s51, s59, 129024
    buffer_load_dwordx4 v3, s[40:43], s51 offen sc1 lds
    s_add_u32 m0, s52, 4352
    s_add_u32 s51, s59, 133120
    buffer_load_dwordx4 v3, s[40:43], s51 offen sc1 lds
    s_add_u32 m0, s68, 8704
    s_add_u32 s51, s67, 137216
    s_mov_b64 exec, 0xfffffff
    buffer_load_dwordx4 v3, s[40:43], s51 offen sc1 lds
    s_mov_b64 exec, -1
    s_add_u32 s68, s68, 9152
    s_cmp_ge_u32 s68, 27456
    s_cselect_b32 s68, 0, s68
    s_add_u32 m0, s55, 101120
    s_add_u32 s51, s66, 114688
    buffer_load_dwordx4 v1, s[36:39], s51 offen sc1 lds
    s_add_u32 m0, s55, 105216
    s_add_u32 s51, s66, 245760
    buffer_load_dwordx4 v1, s[36:39], s51 offen sc1 lds
    s_add_u32 m0, s55, 109312
    s_add_u32 s51, s66, 376832
    buffer_load_dwordx4 v1, s[36:39], s51 offen sc1 lds
    s_add_u32 m0, s55, 113408
    s_add_u32 s51, s66, 507904
    buffer_load_dwordx4 v1, s[36:39], s51 offen sc1 lds
    s_add_u32 m0, s55, 117504
    s_add_u32 s51, s66, 638976
    buffer_load_dwordx4 v1, s[36:39], s51 offen sc1 lds
    s_add_u32 m0, s55, 121600
    s_add_u32 s51, s66, 770048
    buffer_load_dwordx4 v1, s[36:39], s51 offen sc1 lds
    s_add_u32 m0, s55, 125696
    s_add_u32 s51, s66, 901120
    buffer_load_dwordx4 v1, s[36:39], s51 offen sc1 lds
    s_add_u32 m0, s55, 129792
    s_add_u32 s51, s66, 1032192
    buffer_load_dwordx4 v1, s[36:39], s51 offen sc1 lds
    s_waitcnt vmcnt(19)
    s_barrier
    s_add_u32 s52, s71, s68
    s_add_u32 m0, s52, 0
    s_add_u32 s51, s59, 64512
    buffer_load_dwordx4 v3, s[40:43], s51 offen sc1 lds
    s_add_u32 m0, s52, 4352
    s_add_u32 s51, s59, 68608
    buffer_load_dwordx4 v3, s[40:43], s51 offen sc1 lds
    s_add_u32 m0, s68, 8704
    s_add_u32 s51, s67, 72704
    s_mov_b64 exec, 0xfffffff
    buffer_load_dwordx4 v3, s[40:43], s51 offen sc1 lds
    s_mov_b64 exec, -1
    s_add_u32 s68, s68, 9152
    s_cmp_ge_u32 s68, 27456
    s_cselect_b32 s68, 0, s68
    s_add_u32 m0, s55, 133888
    s_add_u32 s51, s66, 1163264
    buffer_load_dwordx4 v1, s[36:39], s51 offen sc1 lds
    s_add_u32 m0, s55, 137984
    s_add_u32 s51, s66, 1294336
    buffer_load_dwordx4 v1, s[36:39], s51 offen sc1 lds
    s_add_u32 m0, s55, 142080
    s_add_u32 s51, s66, 1425408
    buffer_load_dwordx4 v1, s[36:39], s51 offen sc1 lds
    s_add_u32 m0, s55, 146176
    s_add_u32 s51, s66, 1556480
    buffer_load_dwordx4 v1, s[36:39], s51 offen sc1 lds
    s_add_u32 m0, s55, 150272
    s_add_u32 s51, s66, 1687552
    buffer_load_dwordx4 v1, s[36:39], s51 offen sc1 lds
    s_add_u32 m0, s55, 154368
    s_add_u32 s51, s66, 1818624
    buffer_load_dwordx4 v1, s[36:39], s51 offen sc1 lds
    s_add_u32 m0, s55, 158464
    s_add_u32 s51, s66, 1949696
    buffer_load_dwordx4 v1, s[36:39], s51 offen sc1 lds
    s_add_u32 m0, s55, 27456
    s_add_u32 s51, s66, 2080768
    buffer_load_dwordx4 v1, s[36:39], s51 offen sc1 lds
    s_waitcnt vmcnt(19)
    s_barrier
    s_add_u32 s52, s71, s68
    s_add_u32 m0, s52, 0
    s_add_u32 s51, s59, 138240
    buffer_load_dwordx4 v3, s[40:43], s51 offen sc1 lds
    s_add_u32 m0, s52, 4352
    s_add_u32 s51, s59, 142336
    buffer_load_dwordx4 v3, s[40:43], s51 offen sc1 lds
    s_add_u32 m0, s68, 8704
    s_add_u32 s51, s67, 146432
    s_mov_b64 exec, 0xfffffff
    buffer_load_dwordx4 v3, s[40:43], s51 offen sc1 lds
    s_mov_b64 exec, -1
    s_add_u32 s68, s68, 9152
    s_cmp_ge_u32 s68, 27456
    s_cselect_b32 s68, 0, s68
    s_waitcnt vmcnt(11)
    s_barrier
    s_waitcnt vmcnt(0)
    s_barrier
    s_waitcnt vmcnt(0)
    s_barrier
    s_mul_i32 s69, s47, 4088320
    s_mul_i32 s52, s48, 130560
    s_add_u32 s69, s69, s52
    s_add_u32 s69, s69, s50
    s_lshl_b32 s51, s75, 2
    s_add_u32 s51, s51, s44
    s_lshl_b32 s52, s51, 5
    v_lshrrev_b32 v7, 3, v0
    v_add_u32 v7, s52, v7
    v_and_b32 v3, 7, v0
    v_lshlrev_b32 v4, 9, v7
    v_lshlrev_b32 v8, 4, v3
    v_add_u32 v4, v4, v8
    v_lshlrev_b32 v2, 5, v3
    v_add_u32 v2, 40960, v2
    v_lshlrev_b32 v8, 8, v7
    v_add_u32 v8, 65536, v8
    v_lshlrev_b32 v3, 1, v3
    s_lshl_b32 s51, s51, 1
    v_or_b32 v176, 0, v3
    s_add_u32 s52, s51, 0
    v_xor_b32 v176, s52, v176
    v_lshlrev_b32 v176, 4, v176
    v_add_u32 v176, v176, v8
    v_or_b32 v177, 1, v3
    s_add_u32 s52, s51, 0
    v_xor_b32 v177, s52, v177
    v_lshlrev_b32 v177, 4, v177
    v_add_u32 v177, v177, v8
    v_or_b32 v178, 0, v3
    s_add_u32 s52, s51, 1
    v_xor_b32 v178, s52, v178
    v_lshlrev_b32 v178, 4, v178
    v_add_u32 v178, v178, v8
    v_or_b32 v179, 1, v3
    s_add_u32 s52, s51, 1
    v_xor_b32 v179, s52, v179
    v_lshlrev_b32 v179, 4, v179
    v_add_u32 v179, v179, v8
    v_mov_b32 v168, 0xc0135761
    v_mov_b32 v170, 0xbdd2d3e8
    v_mov_b32 v172, 1.0
    v_mov_b32 v169, 0xc0135761
    v_mov_b32 v171, 0xbdd2d3e8
    v_mov_b32 v173, 1.0
    v_mov_b32 v6, 41472
    s_cmp_eq_u32 s48, 31
    s_movk_i32 s68, 255
    s_cselect_b32 s68, 80, s68
    s_barrier
    ds_read_b128 v[84:87], v176 offset:0
    ds_read_b128 v[88:91], v177 offset:0
    ds_read_b128 v[92:95], v176 offset:2048
    ds_read_b128 v[96:99], v177 offset:2048
    ds_read_b128 v[100:103], v178 offset:4096
    ds_read_b128 v[104:107], v179 offset:4096
    ds_read_b128 v[108:111], v178 offset:6144
    ds_read_b128 v[112:115], v179 offset:6144
    s_branch L_final
L_consumer:
    s_getpc_b64 s[62:63]
L_pc:
    s_sub_u32 s62, s62, L_pc-standalone__self_sup_conv_stem_wavlm__speech_kernel
    s_subb_u32 s63, s63, 0
    v_lshlrev_b32 v194, 7, v19
    v_min_u32 v194, L_end-standalone__self_sup_conv_stem_wavlm__speech_kernel, v194
    global_load_dword v193, v194, s[62:63]
    v_lshlrev_b32 v194, 4, v19
    v_add_u32 v194, 0x8000, v194
    v_min_u32 v194, L_end-standalone__self_sup_conv_stem_wavlm__speech_kernel, v194
    global_load_dword v193, v194, s[62:63]
    s_setprio 2
    s_mov_b32 s28, s12
    s_and_b32 s29, s13, 0xffff
    s_mov_b32 s30, 8176640
    s_mov_b32 s31, 0x00020000
    s_mov_b32 s32, s16
    s_and_b32 s33, s17, 0xffff
    s_mov_b32 s34, 139264
    s_mov_b32 s35, 0x00020000
    s_add_u32 s36, s16, 1048576
    s_addc_u32 s37, s17, 0
    s_and_b32 s37, s37, 0xffff
    s_mov_b32 s38, 2097152
    s_mov_b32 s39, 0x00020000
    s_add_u32 s40, s16, 4194304
    s_addc_u32 s41, s17, 0
    s_and_b32 s41, s41, 0xffff
    s_mov_b32 s42, 9437184
    s_mov_b32 s43, 0x00020000
    s_lshr_b32 s51, s2, 4
    s_lshr_b32 s52, s51, 3
    s_and_b32 s53, s51, 7
    s_lshl_b32 s53, s53, 2
    s_add_u32 s53, s53, s52
    s_lshl_b32 s53, s53, 17
    s_and_b32 s52, s2, 15
    s_lshl_b32 s52, s52, 13
    s_add_u32 s55, s53, s52
    s_lshl_b32 s51, s51, 17
    s_add_u32 s57, s51, s52
    s_add_u32 s56, s55, 262144
    v_lshlrev_b32 v18, 5, v19
    buffer_load_dwordx4 v[84:87], v18, s[24:27], s55 offen
    buffer_load_dwordx4 v[88:91], v18, s[24:27], s55 offen offset:16
    buffer_load_dwordx4 v[92:95], v18, s[24:27], s56 offen
    buffer_load_dwordx4 v[96:99], v18, s[24:27], s56 offen offset:16
    v_and_b32 v10, 15, v0
    v_lshrrev_b32 v11, 4, v0
    s_lshl_b32 s53, s44, 5
    s_add_u32 s53, s53, s50
    v_lshlrev_b32 v17, 3, v11
    v_add_u32 v17, s53, v17
    global_load_dwordx2 v[12:13], v17, s[8:9]
    global_load_dwordx2 v[14:15], v17, s[10:11]
    s_lshl_b32 s72, s47, 4
    s_lshl_b32 s53, s45, 2
    s_add_u32 s72, s72, s53
    s_add_u32 s72, s72, s44
    s_lshl_b32 s72, s72, 12
    v_lshlrev_b32 v16, 4, v11
    s_lshl_b32 s58, s48, 7
    s_add_u32 s58, s58, s72
    v_mov_b32 v20, 0
    v_mov_b32 v21, 0
    v_mov_b32 v22, 0
    v_mov_b32 v23, 0
    v_mov_b32 v24, 0
    v_mov_b32 v25, 0
    v_mov_b32 v26, 0
    v_mov_b32 v27, 0
    v_mov_b32 v28, 0
    v_mov_b32 v29, 0
    v_mov_b32 v30, 0
    v_mov_b32 v31, 0
    v_mov_b32 v32, 0
    v_mov_b32 v33, 0
    v_mov_b32 v34, 0
    v_mov_b32 v35, 0
    v_mov_b32 v36, 0
    v_mov_b32 v37, 0
    v_mov_b32 v38, 0
    v_mov_b32 v39, 0
    v_mov_b32 v40, 0
    v_mov_b32 v41, 0
    v_mov_b32 v42, 0
    v_mov_b32 v43, 0
    v_mov_b32 v44, 0
    v_mov_b32 v45, 0
    v_mov_b32 v46, 0
    v_mov_b32 v47, 0
    v_mov_b32 v48, 0
    v_mov_b32 v49, 0
    v_mov_b32 v50, 0
    v_mov_b32 v51, 0
    v_mov_b32 v52, 0
    v_mov_b32 v53, 0
    v_mov_b32 v54, 0
    v_mov_b32 v55, 0
    v_mov_b32 v56, 0
    v_mov_b32 v57, 0
    v_mov_b32 v58, 0
    v_mov_b32 v59, 0
    v_mov_b32 v60, 0
    v_mov_b32 v61, 0
    v_mov_b32 v62, 0
    v_mov_b32 v63, 0
    v_mov_b32 v64, 0
    v_mov_b32 v65, 0
    v_mov_b32 v66, 0
    v_mov_b32 v67, 0
    v_mov_b32 v68, 0
    v_mov_b32 v69, 0
    v_mov_b32 v70, 0
    v_mov_b32 v71, 0
    v_mov_b32 v72, 0
    v_mov_b32 v73, 0
    v_mov_b32 v74, 0
    v_mov_b32 v75, 0
    v_mov_b32 v76, 0
    v_mov_b32 v77, 0
    v_mov_b32 v78, 0
    v_mov_b32 v79, 0
    v_mov_b32 v80, 0
    v_mov_b32 v81, 0
    v_mov_b32 v82, 0
    v_mov_b32 v83, 0
    v_mov_b32 v196, 0
    v_mov_b32 v197, 0
    v_mov_b32 v198, 0
    v_mov_b32 v199, 0
    s_lshl_b32 s73, s46, 7
    s_lshl_b32 s51, s45, 2
    s_add_u32 s73, s73, s51
    s_add_u32 s73, s73, 131072
    v_mul_u32_u24 v17, 1056, v10
    v_lshlrev_b32 v3, 4, v11
    v_add_u32 v195, v17, v3
    v_mov_b32 v17, v10
    v_and_b32 v3, 1, v17
    v_lshrrev_b32 v17, 1, v17
    v_mul_u32_u24 v17, 1088, v17
    v_lshlrev_b32 v4, 9, v3
    v_add_u32 v17, v17, v4
    v_lshlrev_b32 v3, 1, v3
    v_xor_b32 v3, v3, v11
    v_lshlrev_b32 v3, 4, v3
    v_add_u32 v1, v17, v3
    v_add_u32 v17, 1, v10
    v_and_b32 v3, 1, v17
    v_lshrrev_b32 v17, 1, v17
    v_mul_u32_u24 v17, 1088, v17
    v_lshlrev_b32 v4, 9, v3
    v_add_u32 v17, v17, v4
    v_lshlrev_b32 v3, 1, v3
    v_xor_b32 v3, v3, v11
    v_lshlrev_b32 v3, 4, v3
    v_add_u32 v2, v17, v3
    v_lshrrev_b32 v3, 2, v10
    v_and_b32 v4, 3, v0
    v_lshrrev_b32 v5, 1, v3
    v_and_b32 v6, 1, v11
    v_lshlrev_b32 v6, 1, v6
    v_or_b32 v5, v5, v6
    v_xor_b32 v5, s44, v5
    v_lshlrev_b32 v5, 5, v5
    v_lshlrev_b32 v4, 3, v4
    v_add_u32 v5, v5, v4
    v_lshlrev_b32 v3, 7, v3
    v_add_u32 v5, v5, v3
    v_lshlrev_b32 v3, 10, v11
    v_add_u32 v7, v5, v3
    v_add_u32 v8, 0x10000, v7
    v_add_u32 v9, 0x20000, v7
    v_mov_b32 v3, v1
    v_mov_b32 v4, v2
    s_mov_b32 s60, 0
    s_mov_b32 s54, 0
    s_waitcnt lgkmcnt(0)
    s_barrier
    ds_read_b64_tr_b16 v[176:177], v7 offset:35584
    ds_read_b64_tr_b16 v[178:179], v7 offset:36096
    ds_read_b128 v[116:119], v195 offset:0
    ds_read_b128 v[120:123], v195 offset:128
    ds_read_b64_tr_b16 v[180:181], v7 offset:39680
    ds_read_b64_tr_b16 v[182:183], v7 offset:40192
    ds_read_b128 v[124:127], v195 offset:256
    ds_read_b128 v[128:131], v195 offset:384
    ds_read_b128 v[132:135], v195 offset:512
    ds_read_b128 v[136:139], v195 offset:640
    ds_read_b128 v[140:143], v195 offset:768
    ds_read_b128 v[144:147], v195 offset:896
    ds_read_b128 v[148:151], v195 offset:1056
L_p1:
    s_waitcnt lgkmcnt(10)
    v_mfma_f32_16x16x32_bf16 v[20:23], v[176:179], v[116:119], v[20:23]
    ds_read_b64_tr_b16 v[184:185], v7 offset:43776
    s_waitcnt lgkmcnt(8)
    v_mfma_f32_16x16x32_bf16 v[20:23], v[180:183], v[120:123], v[20:23]
    ds_read_b64_tr_b16 v[186:187], v7 offset:44288
    v_mfma_f32_16x16x32_bf16 v[24:27], v[176:179], v[120:123], v[24:27]
    ds_read_b64_tr_b16 v[188:189], v7 offset:47872
    s_waitcnt lgkmcnt(9)
    v_mfma_f32_16x16x32_bf16 v[24:27], v[180:183], v[124:127], v[24:27]
    ds_read_b64_tr_b16 v[190:191], v7 offset:48384
    v_mfma_f32_16x16x32_bf16 v[28:31], v[176:179], v[124:127], v[28:31]
    ds_read_b128 v[152:155], v195 offset:1184
    s_waitcnt lgkmcnt(10)
    v_mfma_f32_16x16x32_bf16 v[28:31], v[180:183], v[128:131], v[28:31]
    ds_read_b128 v[156:159], v195 offset:1312
    v_mfma_f32_16x16x32_bf16 v[32:35], v[176:179], v[128:131], v[32:35]
    s_waitcnt lgkmcnt(10)
    v_mfma_f32_16x16x32_bf16 v[32:35], v[180:183], v[132:135], v[32:35]
    v_mfma_f32_16x16x32_bf16 v[36:39], v[176:179], v[132:135], v[36:39]
    s_waitcnt lgkmcnt(9)
    v_mfma_f32_16x16x32_bf16 v[36:39], v[180:183], v[136:139], v[36:39]
    v_mfma_f32_16x16x32_bf16 v[40:43], v[176:179], v[136:139], v[40:43]
    s_waitcnt lgkmcnt(8)
    v_mfma_f32_16x16x32_bf16 v[40:43], v[180:183], v[140:143], v[40:43]
    v_mfma_f32_16x16x32_bf16 v[44:47], v[176:179], v[140:143], v[44:47]
    s_waitcnt lgkmcnt(7)
    v_mfma_f32_16x16x32_bf16 v[44:47], v[180:183], v[144:147], v[44:47]
    v_mfma_f32_16x16x32_bf16 v[48:51], v[176:179], v[144:147], v[48:51]
    s_waitcnt lgkmcnt(6)
    v_mfma_f32_16x16x32_bf16 v[48:51], v[180:183], v[148:151], v[48:51]
    s_waitcnt lgkmcnt(4)
    v_mfma_f32_16x16x32_bf16 v[20:23], v[184:187], v[124:127], v[20:23]
    ds_read_b64_tr_b16 v[176:177], v7 offset:51968
    s_waitcnt lgkmcnt(3)
    v_mfma_f32_16x16x32_bf16 v[20:23], v[188:191], v[128:131], v[20:23]
    ds_read_b64_tr_b16 v[178:179], v7 offset:52480
    v_mfma_f32_16x16x32_bf16 v[24:27], v[184:187], v[128:131], v[24:27]
    ds_read_b64_tr_b16 v[180:181], v7 offset:56064
    v_mfma_f32_16x16x32_bf16 v[24:27], v[188:191], v[132:135], v[24:27]
    ds_read_b64_tr_b16 v[182:183], v7 offset:56576
    v_mfma_f32_16x16x32_bf16 v[28:31], v[184:187], v[132:135], v[28:31]
    ds_read_b128 v[160:163], v195 offset:1440
    v_mfma_f32_16x16x32_bf16 v[28:31], v[188:191], v[136:139], v[28:31]
    ds_read_b128 v[164:167], v195 offset:1568
    v_mfma_f32_16x16x32_bf16 v[32:35], v[184:187], v[136:139], v[32:35]
    v_mfma_f32_16x16x32_bf16 v[32:35], v[188:191], v[140:143], v[32:35]
    v_mfma_f32_16x16x32_bf16 v[36:39], v[184:187], v[140:143], v[36:39]
    v_mfma_f32_16x16x32_bf16 v[36:39], v[188:191], v[144:147], v[36:39]
    v_mfma_f32_16x16x32_bf16 v[40:43], v[184:187], v[144:147], v[40:43]
    v_mfma_f32_16x16x32_bf16 v[40:43], v[188:191], v[148:151], v[40:43]
    v_mfma_f32_16x16x32_bf16 v[44:47], v[184:187], v[148:151], v[44:47]
    s_waitcnt lgkmcnt(7)
    v_mfma_f32_16x16x32_bf16 v[44:47], v[188:191], v[152:155], v[44:47]
    v_mfma_f32_16x16x32_bf16 v[48:51], v[184:187], v[152:155], v[48:51]
    s_waitcnt lgkmcnt(6)
    v_mfma_f32_16x16x32_bf16 v[48:51], v[188:191], v[156:159], v[48:51]
    s_waitcnt lgkmcnt(4)
    v_mfma_f32_16x16x32_bf16 v[20:23], v[176:179], v[132:135], v[20:23]
    ds_read_b64_tr_b16 v[184:185], v7 offset:60160
    s_waitcnt lgkmcnt(3)
    v_mfma_f32_16x16x32_bf16 v[20:23], v[180:183], v[136:139], v[20:23]
    ds_read_b64_tr_b16 v[186:187], v7 offset:60672
    v_mfma_f32_16x16x32_bf16 v[24:27], v[176:179], v[136:139], v[24:27]
    ds_read_b64_tr_b16 v[188:189], v7 offset:64256
    v_mfma_f32_16x16x32_bf16 v[24:27], v[180:183], v[140:143], v[24:27]
    ds_read_b64_tr_b16 v[190:191], v7 offset:64768
    v_mfma_f32_16x16x32_bf16 v[28:31], v[176:179], v[140:143], v[28:31]
    ds_read_b128 v[168:171], v195 offset:1696
    v_mfma_f32_16x16x32_bf16 v[28:31], v[180:183], v[144:147], v[28:31]
    ds_read_b128 v[172:175], v195 offset:1824
    v_mfma_f32_16x16x32_bf16 v[32:35], v[176:179], v[144:147], v[32:35]
    v_mfma_f32_16x16x32_bf16 v[32:35], v[180:183], v[148:151], v[32:35]
    v_mfma_f32_16x16x32_bf16 v[36:39], v[176:179], v[148:151], v[36:39]
    v_mfma_f32_16x16x32_bf16 v[36:39], v[180:183], v[152:155], v[36:39]
    v_mfma_f32_16x16x32_bf16 v[40:43], v[176:179], v[152:155], v[40:43]
    v_mfma_f32_16x16x32_bf16 v[40:43], v[180:183], v[156:159], v[40:43]
    v_mfma_f32_16x16x32_bf16 v[44:47], v[176:179], v[156:159], v[44:47]
    s_waitcnt lgkmcnt(7)
    v_mfma_f32_16x16x32_bf16 v[44:47], v[180:183], v[160:163], v[44:47]
    v_mfma_f32_16x16x32_bf16 v[48:51], v[176:179], v[160:163], v[48:51]
    s_waitcnt lgkmcnt(6)
    v_mfma_f32_16x16x32_bf16 v[48:51], v[180:183], v[164:167], v[48:51]
    s_waitcnt lgkmcnt(0)
    s_barrier
    v_mfma_f32_16x16x32_bf16 v[20:23], v[184:187], v[140:143], v[20:23]
    ds_read_b64_tr_b16 v[176:177], v8 offset:2816
    v_mfma_f32_16x16x32_bf16 v[20:23], v[188:191], v[144:147], v[20:23]
    ds_read_b64_tr_b16 v[178:179], v8 offset:3328
    v_mfma_f32_16x16x32_bf16 v[24:27], v[184:187], v[144:147], v[24:27]
    ds_read_b128 v[116:119], v195 offset:64
    v_mfma_f32_16x16x32_bf16 v[24:27], v[188:191], v[148:151], v[24:27]
    ds_read_b128 v[120:123], v195 offset:192
    v_mfma_f32_16x16x32_bf16 v[28:31], v[184:187], v[148:151], v[28:31]
    ds_read_b64_tr_b16 v[180:181], v8 offset:6912
    v_mfma_f32_16x16x32_bf16 v[28:31], v[188:191], v[152:155], v[28:31]
    ds_read_b64_tr_b16 v[182:183], v8 offset:7424
    v_mfma_f32_16x16x32_bf16 v[32:35], v[184:187], v[152:155], v[32:35]
    ds_read_b128 v[124:127], v195 offset:320
    v_mfma_f32_16x16x32_bf16 v[32:35], v[188:191], v[156:159], v[32:35]
    ds_read_b128 v[128:131], v195 offset:448
    v_mfma_f32_16x16x32_bf16 v[36:39], v[184:187], v[156:159], v[36:39]
    ds_read_b128 v[132:135], v195 offset:576
    v_mfma_f32_16x16x32_bf16 v[36:39], v[188:191], v[160:163], v[36:39]
    ds_read_b128 v[136:139], v195 offset:704
    v_mfma_f32_16x16x32_bf16 v[40:43], v[184:187], v[160:163], v[40:43]
    ds_read_b128 v[140:143], v195 offset:832
    v_mfma_f32_16x16x32_bf16 v[40:43], v[188:191], v[164:167], v[40:43]
    ds_read_b128 v[144:147], v195 offset:960
    v_mfma_f32_16x16x32_bf16 v[44:47], v[184:187], v[164:167], v[44:47]
    ds_read_b128 v[148:151], v195 offset:1120
    v_mfma_f32_16x16x32_bf16 v[44:47], v[188:191], v[168:171], v[44:47]
    v_mfma_f32_16x16x32_bf16 v[48:51], v[184:187], v[168:171], v[48:51]
    v_mfma_f32_16x16x32_bf16 v[48:51], v[188:191], v[172:175], v[48:51]
    s_waitcnt lgkmcnt(10)
    v_mfma_f32_16x16x32_bf16 v[20:23], v[176:179], v[116:119], v[20:23]
    ds_read_b64_tr_b16 v[184:185], v8 offset:11008
    s_waitcnt lgkmcnt(8)
    v_mfma_f32_16x16x32_bf16 v[20:23], v[180:183], v[120:123], v[20:23]
    ds_read_b64_tr_b16 v[186:187], v8 offset:11520
    v_mfma_f32_16x16x32_bf16 v[24:27], v[176:179], v[120:123], v[24:27]
    ds_read_b64_tr_b16 v[188:189], v8 offset:15104
    s_waitcnt lgkmcnt(9)
    v_mfma_f32_16x16x32_bf16 v[24:27], v[180:183], v[124:127], v[24:27]
    ds_read_b64_tr_b16 v[190:191], v8 offset:15616
    v_mfma_f32_16x16x32_bf16 v[28:31], v[176:179], v[124:127], v[28:31]
    ds_read_b128 v[152:155], v195 offset:1248
    s_waitcnt lgkmcnt(10)
    v_mfma_f32_16x16x32_bf16 v[28:31], v[180:183], v[128:131], v[28:31]
    ds_read_b128 v[156:159], v195 offset:1376
    v_mfma_f32_16x16x32_bf16 v[32:35], v[176:179], v[128:131], v[32:35]
    s_waitcnt lgkmcnt(10)
    v_mfma_f32_16x16x32_bf16 v[32:35], v[180:183], v[132:135], v[32:35]
    v_mfma_f32_16x16x32_bf16 v[36:39], v[176:179], v[132:135], v[36:39]
    s_waitcnt lgkmcnt(9)
    v_mfma_f32_16x16x32_bf16 v[36:39], v[180:183], v[136:139], v[36:39]
    v_mfma_f32_16x16x32_bf16 v[40:43], v[176:179], v[136:139], v[40:43]
    s_waitcnt lgkmcnt(8)
    v_mfma_f32_16x16x32_bf16 v[40:43], v[180:183], v[140:143], v[40:43]
    v_mfma_f32_16x16x32_bf16 v[44:47], v[176:179], v[140:143], v[44:47]
    s_waitcnt lgkmcnt(7)
    v_mfma_f32_16x16x32_bf16 v[44:47], v[180:183], v[144:147], v[44:47]
    v_mfma_f32_16x16x32_bf16 v[48:51], v[176:179], v[144:147], v[48:51]
    s_waitcnt lgkmcnt(6)
    v_mfma_f32_16x16x32_bf16 v[48:51], v[180:183], v[148:151], v[48:51]
    s_waitcnt lgkmcnt(4)
    v_mfma_f32_16x16x32_bf16 v[20:23], v[184:187], v[124:127], v[20:23]
    ds_read_b64_tr_b16 v[176:177], v8 offset:19200
    s_waitcnt lgkmcnt(3)
    v_mfma_f32_16x16x32_bf16 v[20:23], v[188:191], v[128:131], v[20:23]
    ds_read_b64_tr_b16 v[178:179], v8 offset:19712
    v_mfma_f32_16x16x32_bf16 v[24:27], v[184:187], v[128:131], v[24:27]
    ds_read_b64_tr_b16 v[180:181], v8 offset:23296
    v_mfma_f32_16x16x32_bf16 v[24:27], v[188:191], v[132:135], v[24:27]
    ds_read_b64_tr_b16 v[182:183], v8 offset:23808
    v_mfma_f32_16x16x32_bf16 v[28:31], v[184:187], v[132:135], v[28:31]
    ds_read_b128 v[160:163], v195 offset:1504
    v_mfma_f32_16x16x32_bf16 v[28:31], v[188:191], v[136:139], v[28:31]
    ds_read_b128 v[164:167], v195 offset:1632
    v_mfma_f32_16x16x32_bf16 v[32:35], v[184:187], v[136:139], v[32:35]
    v_mfma_f32_16x16x32_bf16 v[32:35], v[188:191], v[140:143], v[32:35]
    v_mfma_f32_16x16x32_bf16 v[36:39], v[184:187], v[140:143], v[36:39]
    v_mfma_f32_16x16x32_bf16 v[36:39], v[188:191], v[144:147], v[36:39]
    v_mfma_f32_16x16x32_bf16 v[40:43], v[184:187], v[144:147], v[40:43]
    v_mfma_f32_16x16x32_bf16 v[40:43], v[188:191], v[148:151], v[40:43]
    v_mfma_f32_16x16x32_bf16 v[44:47], v[184:187], v[148:151], v[44:47]
    s_waitcnt lgkmcnt(7)
    v_mfma_f32_16x16x32_bf16 v[44:47], v[188:191], v[152:155], v[44:47]
    v_mfma_f32_16x16x32_bf16 v[48:51], v[184:187], v[152:155], v[48:51]
    s_waitcnt lgkmcnt(6)
    v_mfma_f32_16x16x32_bf16 v[48:51], v[188:191], v[156:159], v[48:51]
    s_waitcnt lgkmcnt(4)
    v_mfma_f32_16x16x32_bf16 v[20:23], v[176:179], v[132:135], v[20:23]
    ds_read_b64_tr_b16 v[184:185], v8 offset:27392
    s_waitcnt lgkmcnt(3)
    v_mfma_f32_16x16x32_bf16 v[20:23], v[180:183], v[136:139], v[20:23]
    ds_read_b64_tr_b16 v[186:187], v8 offset:27904
    v_mfma_f32_16x16x32_bf16 v[24:27], v[176:179], v[136:139], v[24:27]
    ds_read_b64_tr_b16 v[188:189], v8 offset:31488
    v_mfma_f32_16x16x32_bf16 v[24:27], v[180:183], v[140:143], v[24:27]
    ds_read_b64_tr_b16 v[190:191], v8 offset:32000
    v_mfma_f32_16x16x32_bf16 v[28:31], v[176:179], v[140:143], v[28:31]
    ds_read_b128 v[168:171], v195 offset:1760
    v_mfma_f32_16x16x32_bf16 v[28:31], v[180:183], v[144:147], v[28:31]
    ds_read_b128 v[172:175], v195 offset:1888
    v_mfma_f32_16x16x32_bf16 v[32:35], v[176:179], v[144:147], v[32:35]
    v_mfma_f32_16x16x32_bf16 v[32:35], v[180:183], v[148:151], v[32:35]
    v_mfma_f32_16x16x32_bf16 v[36:39], v[176:179], v[148:151], v[36:39]
    v_mfma_f32_16x16x32_bf16 v[36:39], v[180:183], v[152:155], v[36:39]
    v_mfma_f32_16x16x32_bf16 v[40:43], v[176:179], v[152:155], v[40:43]
    v_mfma_f32_16x16x32_bf16 v[40:43], v[180:183], v[156:159], v[40:43]
    v_mfma_f32_16x16x32_bf16 v[44:47], v[176:179], v[156:159], v[44:47]
    s_waitcnt lgkmcnt(7)
    v_mfma_f32_16x16x32_bf16 v[44:47], v[180:183], v[160:163], v[44:47]
    v_mfma_f32_16x16x32_bf16 v[48:51], v[176:179], v[160:163], v[48:51]
    s_waitcnt lgkmcnt(6)
    v_mfma_f32_16x16x32_bf16 v[48:51], v[180:183], v[164:167], v[48:51]
    s_waitcnt lgkmcnt(0)
    s_barrier
    v_mfma_f32_16x16x32_bf16 v[20:23], v[184:187], v[140:143], v[20:23]
    ds_read_b64_tr_b16 v[176:177], v8 offset:35584
    v_mfma_f32_16x16x32_bf16 v[20:23], v[188:191], v[144:147], v[20:23]
    ds_read_b64_tr_b16 v[178:179], v8 offset:36096
    v_mfma_f32_16x16x32_bf16 v[24:27], v[184:187], v[144:147], v[24:27]
    ds_read_b128 v[116:119], v195 offset:17792
    v_mfma_f32_16x16x32_bf16 v[24:27], v[188:191], v[148:151], v[24:27]
    ds_read_b128 v[120:123], v195 offset:17920
    v_mfma_f32_16x16x32_bf16 v[28:31], v[184:187], v[148:151], v[28:31]
    ds_read_b64_tr_b16 v[180:181], v8 offset:39680
    v_mfma_f32_16x16x32_bf16 v[28:31], v[188:191], v[152:155], v[28:31]
    ds_read_b64_tr_b16 v[182:183], v8 offset:40192
    v_mfma_f32_16x16x32_bf16 v[32:35], v[184:187], v[152:155], v[32:35]
    ds_read_b128 v[124:127], v195 offset:18048
    v_mfma_f32_16x16x32_bf16 v[32:35], v[188:191], v[156:159], v[32:35]
    ds_read_b128 v[128:131], v195 offset:18176
    v_mfma_f32_16x16x32_bf16 v[36:39], v[184:187], v[156:159], v[36:39]
    ds_read_b128 v[132:135], v195 offset:18304
    v_mfma_f32_16x16x32_bf16 v[36:39], v[188:191], v[160:163], v[36:39]
    ds_read_b128 v[136:139], v195 offset:18432
    v_mfma_f32_16x16x32_bf16 v[40:43], v[184:187], v[160:163], v[40:43]
    ds_read_b128 v[140:143], v195 offset:18560
    v_mfma_f32_16x16x32_bf16 v[40:43], v[188:191], v[164:167], v[40:43]
    ds_read_b128 v[144:147], v195 offset:18688
    v_mfma_f32_16x16x32_bf16 v[44:47], v[184:187], v[164:167], v[44:47]
    ds_read_b128 v[148:151], v195 offset:18848
    v_mfma_f32_16x16x32_bf16 v[44:47], v[188:191], v[168:171], v[44:47]
    v_mfma_f32_16x16x32_bf16 v[48:51], v[184:187], v[168:171], v[48:51]
    v_mfma_f32_16x16x32_bf16 v[48:51], v[188:191], v[172:175], v[48:51]
    s_waitcnt lgkmcnt(10)
    v_mfma_f32_16x16x32_bf16 v[52:55], v[176:179], v[116:119], v[52:55]
    ds_read_b64_tr_b16 v[184:185], v8 offset:43776
    s_waitcnt lgkmcnt(8)
    v_mfma_f32_16x16x32_bf16 v[52:55], v[180:183], v[120:123], v[52:55]
    ds_read_b64_tr_b16 v[186:187], v8 offset:44288
    v_mfma_f32_16x16x32_bf16 v[56:59], v[176:179], v[120:123], v[56:59]
    ds_read_b64_tr_b16 v[188:189], v8 offset:47872
    s_waitcnt lgkmcnt(9)
    v_mfma_f32_16x16x32_bf16 v[56:59], v[180:183], v[124:127], v[56:59]
    ds_read_b64_tr_b16 v[190:191], v8 offset:48384
    v_mfma_f32_16x16x32_bf16 v[60:63], v[176:179], v[124:127], v[60:63]
    ds_read_b128 v[152:155], v195 offset:18976
    s_waitcnt lgkmcnt(10)
    v_mfma_f32_16x16x32_bf16 v[60:63], v[180:183], v[128:131], v[60:63]
    ds_read_b128 v[156:159], v195 offset:19104
    v_mfma_f32_16x16x32_bf16 v[64:67], v[176:179], v[128:131], v[64:67]
    s_waitcnt lgkmcnt(10)
    v_mfma_f32_16x16x32_bf16 v[64:67], v[180:183], v[132:135], v[64:67]
    v_mfma_f32_16x16x32_bf16 v[68:71], v[176:179], v[132:135], v[68:71]
    s_waitcnt lgkmcnt(9)
    v_mfma_f32_16x16x32_bf16 v[68:71], v[180:183], v[136:139], v[68:71]
    v_mfma_f32_16x16x32_bf16 v[72:75], v[176:179], v[136:139], v[72:75]
    s_waitcnt lgkmcnt(8)
    v_mfma_f32_16x16x32_bf16 v[72:75], v[180:183], v[140:143], v[72:75]
    v_mfma_f32_16x16x32_bf16 v[76:79], v[176:179], v[140:143], v[76:79]
    s_waitcnt lgkmcnt(7)
    v_mfma_f32_16x16x32_bf16 v[76:79], v[180:183], v[144:147], v[76:79]
    v_mfma_f32_16x16x32_bf16 v[80:83], v[176:179], v[144:147], v[80:83]
    s_waitcnt lgkmcnt(6)
    v_mfma_f32_16x16x32_bf16 v[80:83], v[180:183], v[148:151], v[80:83]
    s_waitcnt lgkmcnt(4)
    v_mfma_f32_16x16x32_bf16 v[52:55], v[184:187], v[124:127], v[52:55]
    ds_read_b64_tr_b16 v[176:177], v8 offset:51968
    s_waitcnt lgkmcnt(3)
    v_mfma_f32_16x16x32_bf16 v[52:55], v[188:191], v[128:131], v[52:55]
    ds_read_b64_tr_b16 v[178:179], v8 offset:52480
    v_mfma_f32_16x16x32_bf16 v[56:59], v[184:187], v[128:131], v[56:59]
    ds_read_b64_tr_b16 v[180:181], v8 offset:56064
    v_mfma_f32_16x16x32_bf16 v[56:59], v[188:191], v[132:135], v[56:59]
    ds_read_b64_tr_b16 v[182:183], v8 offset:56576
    v_mfma_f32_16x16x32_bf16 v[60:63], v[184:187], v[132:135], v[60:63]
    ds_read_b128 v[160:163], v195 offset:19232
    v_mfma_f32_16x16x32_bf16 v[60:63], v[188:191], v[136:139], v[60:63]
    ds_read_b128 v[164:167], v195 offset:19360
    v_mfma_f32_16x16x32_bf16 v[64:67], v[184:187], v[136:139], v[64:67]
    v_mfma_f32_16x16x32_bf16 v[64:67], v[188:191], v[140:143], v[64:67]
    v_mfma_f32_16x16x32_bf16 v[68:71], v[184:187], v[140:143], v[68:71]
    v_mfma_f32_16x16x32_bf16 v[68:71], v[188:191], v[144:147], v[68:71]
    v_mfma_f32_16x16x32_bf16 v[72:75], v[184:187], v[144:147], v[72:75]
    v_mfma_f32_16x16x32_bf16 v[72:75], v[188:191], v[148:151], v[72:75]
    v_mfma_f32_16x16x32_bf16 v[76:79], v[184:187], v[148:151], v[76:79]
    s_waitcnt lgkmcnt(7)
    v_mfma_f32_16x16x32_bf16 v[76:79], v[188:191], v[152:155], v[76:79]
    v_mfma_f32_16x16x32_bf16 v[80:83], v[184:187], v[152:155], v[80:83]
    s_waitcnt lgkmcnt(6)
    v_mfma_f32_16x16x32_bf16 v[80:83], v[188:191], v[156:159], v[80:83]
    s_waitcnt lgkmcnt(4)
    v_mfma_f32_16x16x32_bf16 v[52:55], v[176:179], v[132:135], v[52:55]
    ds_read_b64_tr_b16 v[184:185], v8 offset:60160
    s_waitcnt lgkmcnt(3)
    v_mfma_f32_16x16x32_bf16 v[52:55], v[180:183], v[136:139], v[52:55]
    ds_read_b64_tr_b16 v[186:187], v8 offset:60672
    v_mfma_f32_16x16x32_bf16 v[56:59], v[176:179], v[136:139], v[56:59]
    ds_read_b64_tr_b16 v[188:189], v8 offset:64256
    v_mfma_f32_16x16x32_bf16 v[56:59], v[180:183], v[140:143], v[56:59]
    ds_read_b64_tr_b16 v[190:191], v8 offset:64768
    v_mfma_f32_16x16x32_bf16 v[60:63], v[176:179], v[140:143], v[60:63]
    ds_read_b128 v[168:171], v195 offset:19488
    v_mfma_f32_16x16x32_bf16 v[60:63], v[180:183], v[144:147], v[60:63]
    ds_read_b128 v[172:175], v195 offset:19616
    v_mfma_f32_16x16x32_bf16 v[64:67], v[176:179], v[144:147], v[64:67]
    v_mfma_f32_16x16x32_bf16 v[64:67], v[180:183], v[148:151], v[64:67]
    v_mfma_f32_16x16x32_bf16 v[68:71], v[176:179], v[148:151], v[68:71]
    v_mfma_f32_16x16x32_bf16 v[68:71], v[180:183], v[152:155], v[68:71]
    v_mfma_f32_16x16x32_bf16 v[72:75], v[176:179], v[152:155], v[72:75]
    v_mfma_f32_16x16x32_bf16 v[72:75], v[180:183], v[156:159], v[72:75]
    v_mfma_f32_16x16x32_bf16 v[76:79], v[176:179], v[156:159], v[76:79]
    s_waitcnt lgkmcnt(7)
    v_mfma_f32_16x16x32_bf16 v[76:79], v[180:183], v[160:163], v[76:79]
    v_mfma_f32_16x16x32_bf16 v[80:83], v[176:179], v[160:163], v[80:83]
    s_waitcnt lgkmcnt(6)
    v_mfma_f32_16x16x32_bf16 v[80:83], v[180:183], v[164:167], v[80:83]
    s_waitcnt lgkmcnt(0)
    s_barrier
    v_mfma_f32_16x16x32_bf16 v[52:55], v[184:187], v[140:143], v[52:55]
    ds_read_b64_tr_b16 v[176:177], v9 offset:2816
    v_mfma_f32_16x16x32_bf16 v[52:55], v[188:191], v[144:147], v[52:55]
    ds_read_b64_tr_b16 v[178:179], v9 offset:3328
    v_mfma_f32_16x16x32_bf16 v[56:59], v[184:187], v[144:147], v[56:59]
    ds_read_b128 v[116:119], v195 offset:17856
    v_mfma_f32_16x16x32_bf16 v[56:59], v[188:191], v[148:151], v[56:59]
    ds_read_b128 v[120:123], v195 offset:17984
    v_mfma_f32_16x16x32_bf16 v[60:63], v[184:187], v[148:151], v[60:63]
    ds_read_b64_tr_b16 v[180:181], v9 offset:6912
    v_mfma_f32_16x16x32_bf16 v[60:63], v[188:191], v[152:155], v[60:63]
    ds_read_b64_tr_b16 v[182:183], v9 offset:7424
    v_mfma_f32_16x16x32_bf16 v[64:67], v[184:187], v[152:155], v[64:67]
    ds_read_b128 v[124:127], v195 offset:18112
    v_mfma_f32_16x16x32_bf16 v[64:67], v[188:191], v[156:159], v[64:67]
    ds_read_b128 v[128:131], v195 offset:18240
    v_mfma_f32_16x16x32_bf16 v[68:71], v[184:187], v[156:159], v[68:71]
    ds_read_b128 v[132:135], v195 offset:18368
    v_mfma_f32_16x16x32_bf16 v[68:71], v[188:191], v[160:163], v[68:71]
    ds_read_b128 v[136:139], v195 offset:18496
    v_mfma_f32_16x16x32_bf16 v[72:75], v[184:187], v[160:163], v[72:75]
    ds_read_b128 v[140:143], v195 offset:18624
    v_mfma_f32_16x16x32_bf16 v[72:75], v[188:191], v[164:167], v[72:75]
    ds_read_b128 v[144:147], v195 offset:18752
    v_mfma_f32_16x16x32_bf16 v[76:79], v[184:187], v[164:167], v[76:79]
    ds_read_b128 v[148:151], v195 offset:18912
    v_mfma_f32_16x16x32_bf16 v[76:79], v[188:191], v[168:171], v[76:79]
    v_mfma_f32_16x16x32_bf16 v[80:83], v[184:187], v[168:171], v[80:83]
    v_mfma_f32_16x16x32_bf16 v[80:83], v[188:191], v[172:175], v[80:83]
    s_waitcnt lgkmcnt(10)
    v_mfma_f32_16x16x32_bf16 v[52:55], v[176:179], v[116:119], v[52:55]
    ds_read_b64_tr_b16 v[184:185], v9 offset:11008
    s_waitcnt lgkmcnt(8)
    v_mfma_f32_16x16x32_bf16 v[52:55], v[180:183], v[120:123], v[52:55]
    ds_read_b64_tr_b16 v[186:187], v9 offset:11520
    v_mfma_f32_16x16x32_bf16 v[56:59], v[176:179], v[120:123], v[56:59]
    ds_read_b64_tr_b16 v[188:189], v9 offset:15104
    s_waitcnt lgkmcnt(9)
    v_mfma_f32_16x16x32_bf16 v[56:59], v[180:183], v[124:127], v[56:59]
    ds_read_b64_tr_b16 v[190:191], v9 offset:15616
    v_mfma_f32_16x16x32_bf16 v[60:63], v[176:179], v[124:127], v[60:63]
    ds_read_b128 v[152:155], v195 offset:19040
    s_waitcnt lgkmcnt(10)
    v_mfma_f32_16x16x32_bf16 v[60:63], v[180:183], v[128:131], v[60:63]
    ds_read_b128 v[156:159], v195 offset:19168
    v_mfma_f32_16x16x32_bf16 v[64:67], v[176:179], v[128:131], v[64:67]
    s_waitcnt lgkmcnt(10)
    v_mfma_f32_16x16x32_bf16 v[64:67], v[180:183], v[132:135], v[64:67]
    v_mfma_f32_16x16x32_bf16 v[68:71], v[176:179], v[132:135], v[68:71]
    s_waitcnt lgkmcnt(9)
    v_mfma_f32_16x16x32_bf16 v[68:71], v[180:183], v[136:139], v[68:71]
    v_mfma_f32_16x16x32_bf16 v[72:75], v[176:179], v[136:139], v[72:75]
    s_waitcnt lgkmcnt(8)
    v_mfma_f32_16x16x32_bf16 v[72:75], v[180:183], v[140:143], v[72:75]
    v_mfma_f32_16x16x32_bf16 v[76:79], v[176:179], v[140:143], v[76:79]
    s_waitcnt lgkmcnt(7)
    v_mfma_f32_16x16x32_bf16 v[76:79], v[180:183], v[144:147], v[76:79]
    v_mfma_f32_16x16x32_bf16 v[80:83], v[176:179], v[144:147], v[80:83]
    s_waitcnt lgkmcnt(6)
    v_mfma_f32_16x16x32_bf16 v[80:83], v[180:183], v[148:151], v[80:83]
    s_waitcnt lgkmcnt(4)
    v_mfma_f32_16x16x32_bf16 v[52:55], v[184:187], v[124:127], v[52:55]
    ds_read_b64_tr_b16 v[176:177], v9 offset:19200
    s_waitcnt lgkmcnt(3)
    v_mfma_f32_16x16x32_bf16 v[52:55], v[188:191], v[128:131], v[52:55]
    ds_read_b64_tr_b16 v[178:179], v9 offset:19712
    v_mfma_f32_16x16x32_bf16 v[56:59], v[184:187], v[128:131], v[56:59]
    ds_read_b64_tr_b16 v[180:181], v9 offset:23296
    v_mfma_f32_16x16x32_bf16 v[56:59], v[188:191], v[132:135], v[56:59]
    ds_read_b64_tr_b16 v[182:183], v9 offset:23808
    v_mfma_f32_16x16x32_bf16 v[60:63], v[184:187], v[132:135], v[60:63]
    ds_read_b128 v[160:163], v195 offset:19296
    v_mfma_f32_16x16x32_bf16 v[60:63], v[188:191], v[136:139], v[60:63]
    ds_read_b128 v[164:167], v195 offset:19424
    v_mfma_f32_16x16x32_bf16 v[64:67], v[184:187], v[136:139], v[64:67]
    v_mfma_f32_16x16x32_bf16 v[64:67], v[188:191], v[140:143], v[64:67]
    v_mfma_f32_16x16x32_bf16 v[68:71], v[184:187], v[140:143], v[68:71]
    v_mfma_f32_16x16x32_bf16 v[68:71], v[188:191], v[144:147], v[68:71]
    v_mfma_f32_16x16x32_bf16 v[72:75], v[184:187], v[144:147], v[72:75]
    v_mfma_f32_16x16x32_bf16 v[72:75], v[188:191], v[148:151], v[72:75]
    v_mfma_f32_16x16x32_bf16 v[76:79], v[184:187], v[148:151], v[76:79]
    s_waitcnt lgkmcnt(7)
    v_mfma_f32_16x16x32_bf16 v[76:79], v[188:191], v[152:155], v[76:79]
    v_mfma_f32_16x16x32_bf16 v[80:83], v[184:187], v[152:155], v[80:83]
    s_waitcnt lgkmcnt(6)
    v_mfma_f32_16x16x32_bf16 v[80:83], v[188:191], v[156:159], v[80:83]
    s_waitcnt lgkmcnt(4)
    v_mfma_f32_16x16x32_bf16 v[52:55], v[176:179], v[132:135], v[52:55]
    ds_read_b64_tr_b16 v[184:185], v9 offset:27392
    s_waitcnt lgkmcnt(3)
    v_mfma_f32_16x16x32_bf16 v[52:55], v[180:183], v[136:139], v[52:55]
    ds_read_b64_tr_b16 v[186:187], v9 offset:27904
    v_mfma_f32_16x16x32_bf16 v[56:59], v[176:179], v[136:139], v[56:59]
    ds_read_b64_tr_b16 v[188:189], v7 offset:35584
    v_mfma_f32_16x16x32_bf16 v[56:59], v[180:183], v[140:143], v[56:59]
    ds_read_b64_tr_b16 v[190:191], v7 offset:36096
    v_mfma_f32_16x16x32_bf16 v[60:63], v[176:179], v[140:143], v[60:63]
    ds_read_b128 v[168:171], v195 offset:19552
    v_mfma_f32_16x16x32_bf16 v[60:63], v[180:183], v[144:147], v[60:63]
    ds_read_b128 v[172:175], v195 offset:19680
    v_mfma_f32_16x16x32_bf16 v[64:67], v[176:179], v[144:147], v[64:67]
    v_mfma_f32_16x16x32_bf16 v[64:67], v[180:183], v[148:151], v[64:67]
    v_mfma_f32_16x16x32_bf16 v[68:71], v[176:179], v[148:151], v[68:71]
    v_mfma_f32_16x16x32_bf16 v[68:71], v[180:183], v[152:155], v[68:71]
    v_mfma_f32_16x16x32_bf16 v[72:75], v[176:179], v[152:155], v[72:75]
    v_mfma_f32_16x16x32_bf16 v[72:75], v[180:183], v[156:159], v[72:75]
    v_mfma_f32_16x16x32_bf16 v[76:79], v[176:179], v[156:159], v[76:79]
    s_waitcnt lgkmcnt(7)
    v_mfma_f32_16x16x32_bf16 v[76:79], v[180:183], v[160:163], v[76:79]
    v_mfma_f32_16x16x32_bf16 v[80:83], v[176:179], v[160:163], v[80:83]
    s_waitcnt lgkmcnt(6)
    v_mfma_f32_16x16x32_bf16 v[80:83], v[180:183], v[164:167], v[80:83]
    s_waitcnt lgkmcnt(0)
    s_barrier
    v_mfma_f32_16x16x32_bf16 v[52:55], v[184:187], v[140:143], v[52:55]
    ds_read_b64_tr_b16 v[176:177], v7 offset:39680
    v_mfma_f32_16x16x32_bf16 v[52:55], v[188:191], v[144:147], v[52:55]
    ds_read_b64_tr_b16 v[178:179], v7 offset:40192
    v_mfma_f32_16x16x32_bf16 v[56:59], v[184:187], v[144:147], v[56:59]
    ds_read_b128 v[116:119], v195 offset:0
    v_mfma_f32_16x16x32_bf16 v[56:59], v[188:191], v[148:151], v[56:59]
    ds_read_b128 v[120:123], v195 offset:128
    v_mfma_f32_16x16x32_bf16 v[60:63], v[184:187], v[148:151], v[60:63]
    ds_read_b64_tr_b16 v[180:181], v7 offset:43776
    v_mfma_f32_16x16x32_bf16 v[60:63], v[188:191], v[152:155], v[60:63]
    ds_read_b64_tr_b16 v[182:183], v7 offset:44288
    v_mfma_f32_16x16x32_bf16 v[64:67], v[184:187], v[152:155], v[64:67]
    ds_read_b128 v[124:127], v195 offset:256
    v_mfma_f32_16x16x32_bf16 v[64:67], v[188:191], v[156:159], v[64:67]
    ds_read_b128 v[128:131], v195 offset:384
    v_mfma_f32_16x16x32_bf16 v[68:71], v[184:187], v[156:159], v[68:71]
    ds_read_b128 v[132:135], v195 offset:512
    v_mfma_f32_16x16x32_bf16 v[68:71], v[188:191], v[160:163], v[68:71]
    ds_read_b128 v[136:139], v195 offset:640
    v_mfma_f32_16x16x32_bf16 v[72:75], v[184:187], v[160:163], v[72:75]
    ds_read_b128 v[140:143], v195 offset:768
    v_mfma_f32_16x16x32_bf16 v[72:75], v[188:191], v[164:167], v[72:75]
    ds_read_b128 v[144:147], v195 offset:896
    v_mfma_f32_16x16x32_bf16 v[76:79], v[184:187], v[164:167], v[76:79]
    ds_read_b128 v[148:151], v195 offset:1056
    v_mfma_f32_16x16x32_bf16 v[76:79], v[188:191], v[168:171], v[76:79]
    v_mfma_f32_16x16x32_bf16 v[80:83], v[184:187], v[168:171], v[80:83]
    v_mfma_f32_16x16x32_bf16 v[80:83], v[188:191], v[172:175], v[80:83]
    s_cmp_lg_u32 s54, 0
    s_cbranch_scc1 L_nogs
    s_waitcnt vmcnt(0)
    v_lshlrev_b32 v100, 16, v84
    v_and_b32 v101, 0xffff0000, v84
    v_lshlrev_b32 v102, 16, v92
    v_and_b32 v103, 0xffff0000, v92
    v_pk_add_f32 v[100:101], v[100:101], v[102:103] neg_lo:[0,1] neg_hi:[0,1]
    v_cvt_pk_bf16_f32 v84, v100, v101
    v_lshlrev_b32 v104, 16, v85
    v_and_b32 v105, 0xffff0000, v85
    v_lshlrev_b32 v106, 16, v93
    v_and_b32 v107, 0xffff0000, v93
    v_pk_add_f32 v[104:105], v[104:105], v[106:107] neg_lo:[0,1] neg_hi:[0,1]
    v_cvt_pk_bf16_f32 v85, v104, v105
    v_lshlrev_b32 v100, 16, v86
    v_and_b32 v101, 0xffff0000, v86
    v_lshlrev_b32 v102, 16, v94
    v_and_b32 v103, 0xffff0000, v94
    v_pk_add_f32 v[100:101], v[100:101], v[102:103] neg_lo:[0,1] neg_hi:[0,1]
    v_cvt_pk_bf16_f32 v86, v100, v101
    v_lshlrev_b32 v104, 16, v87
    v_and_b32 v105, 0xffff0000, v87
    v_lshlrev_b32 v106, 16, v95
    v_and_b32 v107, 0xffff0000, v95
    v_pk_add_f32 v[104:105], v[104:105], v[106:107] neg_lo:[0,1] neg_hi:[0,1]
    v_cvt_pk_bf16_f32 v87, v104, v105
    v_lshlrev_b32 v100, 16, v88
    v_and_b32 v101, 0xffff0000, v88
    v_lshlrev_b32 v102, 16, v96
    v_and_b32 v103, 0xffff0000, v96
    v_pk_add_f32 v[100:101], v[100:101], v[102:103] neg_lo:[0,1] neg_hi:[0,1]
    v_cvt_pk_bf16_f32 v88, v100, v101
    v_lshlrev_b32 v104, 16, v89
    v_and_b32 v105, 0xffff0000, v89
    v_lshlrev_b32 v106, 16, v97
    v_and_b32 v107, 0xffff0000, v97
    v_pk_add_f32 v[104:105], v[104:105], v[106:107] neg_lo:[0,1] neg_hi:[0,1]
    v_cvt_pk_bf16_f32 v89, v104, v105
    v_lshlrev_b32 v100, 16, v90
    v_and_b32 v101, 0xffff0000, v90
    v_lshlrev_b32 v102, 16, v98
    v_and_b32 v103, 0xffff0000, v98
    v_pk_add_f32 v[100:101], v[100:101], v[102:103] neg_lo:[0,1] neg_hi:[0,1]
    v_cvt_pk_bf16_f32 v90, v100, v101
    v_lshlrev_b32 v104, 16, v91
    v_and_b32 v105, 0xffff0000, v91
    v_lshlrev_b32 v106, 16, v99
    v_and_b32 v107, 0xffff0000, v99
    v_pk_add_f32 v[104:105], v[104:105], v[106:107] neg_lo:[0,1] neg_hi:[0,1]
    v_cvt_pk_bf16_f32 v91, v104, v105
    buffer_store_dwordx4 v[84:87], v18, s[36:39], s57 offen sc1
    buffer_store_dwordx4 v[88:91], v18, s[36:39], s57 offen offset:16 sc1
    v_cmp_eq_u32 vcc, 0, v10
    s_and_saveexec_b64 s[76:77], vcc
    buffer_store_dwordx4 v[196:199], v16, s[32:35], s58 offen sc1
    buffer_store_dwordx4 v[196:199], v16, s[32:35], s58 offen offset:64 sc1
    s_mov_b64 exec, 15
    v_lshlrev_b32 v192, 4, v0
    buffer_store_dword v196, v192, s[32:35], s73 offen sc1
    s_mov_b64 exec, -1
L_nogs:
    s_cmp_eq_u32 s54, 0
    s_cbranch_scc1 L_nosig
    s_cmp_lg_u32 s44, 0
    s_cbranch_scc1 L_nosig
    s_lshl_b32 s51, s54, 4
    s_sub_u32 s51, s51, 16
    v_mov_b32 v192, s51
    v_mov_b32 v193, 1
    s_mov_b64 exec, 1
    buffer_store_dword v193, v192, s[32:35], s73 offen sc1
    s_cmp_lg_u32 s54, 1
    s_cbranch_scc1 L_nosig_x
    global_atomic_add v192, v193, s[14:15]
L_nosig_x:
    s_mov_b64 exec, -1
    s_nop 3
L_nosig:
    s_waitcnt lgkmcnt(10)
    v_mfma_f32_16x16x32_bf16 v[20:23], v[176:179], v[116:119], v[20:23]
    ds_read_b64_tr_b16 v[184:185], v7 offset:47872
    s_waitcnt lgkmcnt(8)
    v_mfma_f32_16x16x32_bf16 v[20:23], v[180:183], v[120:123], v[20:23]
    ds_read_b64_tr_b16 v[186:187], v7 offset:48384
    v_mfma_f32_16x16x32_bf16 v[24:27], v[176:179], v[120:123], v[24:27]
    ds_read_b64_tr_b16 v[188:189], v7 offset:51968
    s_waitcnt lgkmcnt(9)
    v_mfma_f32_16x16x32_bf16 v[24:27], v[180:183], v[124:127], v[24:27]
    ds_read_b64_tr_b16 v[190:191], v7 offset:52480
    v_mfma_f32_16x16x32_bf16 v[28:31], v[176:179], v[124:127], v[28:31]
    ds_read_b128 v[152:155], v195 offset:1184
    s_waitcnt lgkmcnt(10)
    v_mfma_f32_16x16x32_bf16 v[28:31], v[180:183], v[128:131], v[28:31]
    ds_read_b128 v[156:159], v195 offset:1312
    v_mfma_f32_16x16x32_bf16 v[32:35], v[176:179], v[128:131], v[32:35]
    s_waitcnt lgkmcnt(10)
    v_mfma_f32_16x16x32_bf16 v[32:35], v[180:183], v[132:135], v[32:35]
    v_mfma_f32_16x16x32_bf16 v[36:39], v[176:179], v[132:135], v[36:39]
    s_waitcnt lgkmcnt(9)
    v_mfma_f32_16x16x32_bf16 v[36:39], v[180:183], v[136:139], v[36:39]
    v_mfma_f32_16x16x32_bf16 v[40:43], v[176:179], v[136:139], v[40:43]
    s_waitcnt lgkmcnt(8)
    v_mfma_f32_16x16x32_bf16 v[40:43], v[180:183], v[140:143], v[40:43]
    v_mfma_f32_16x16x32_bf16 v[44:47], v[176:179], v[140:143], v[44:47]
    s_waitcnt lgkmcnt(7)
    v_mfma_f32_16x16x32_bf16 v[44:47], v[180:183], v[144:147], v[44:47]
    v_mfma_f32_16x16x32_bf16 v[48:51], v[176:179], v[144:147], v[48:51]
    s_waitcnt lgkmcnt(6)
    v_mfma_f32_16x16x32_bf16 v[48:51], v[180:183], v[148:151], v[48:51]
    s_waitcnt lgkmcnt(4)
    v_mfma_f32_16x16x32_bf16 v[20:23], v[184:187], v[124:127], v[20:23]
    ds_read_b64_tr_b16 v[176:177], v7 offset:56064
    s_waitcnt lgkmcnt(3)
    v_mfma_f32_16x16x32_bf16 v[20:23], v[188:191], v[128:131], v[20:23]
    ds_read_b64_tr_b16 v[178:179], v7 offset:56576
    v_mfma_f32_16x16x32_bf16 v[24:27], v[184:187], v[128:131], v[24:27]
    ds_read_b64_tr_b16 v[180:181], v7 offset:60160
    v_mfma_f32_16x16x32_bf16 v[24:27], v[188:191], v[132:135], v[24:27]
    ds_read_b64_tr_b16 v[182:183], v7 offset:60672
    v_mfma_f32_16x16x32_bf16 v[28:31], v[184:187], v[132:135], v[28:31]
    ds_read_b128 v[160:163], v195 offset:1440
    v_mfma_f32_16x16x32_bf16 v[28:31], v[188:191], v[136:139], v[28:31]
    ds_read_b128 v[164:167], v195 offset:1568
    v_mfma_f32_16x16x32_bf16 v[32:35], v[184:187], v[136:139], v[32:35]
    v_mfma_f32_16x16x32_bf16 v[32:35], v[188:191], v[140:143], v[32:35]
    v_mfma_f32_16x16x32_bf16 v[36:39], v[184:187], v[140:143], v[36:39]
    v_mfma_f32_16x16x32_bf16 v[36:39], v[188:191], v[144:147], v[36:39]
    v_mfma_f32_16x16x32_bf16 v[40:43], v[184:187], v[144:147], v[40:43]
    v_mfma_f32_16x16x32_bf16 v[40:43], v[188:191], v[148:151], v[40:43]
    v_mfma_f32_16x16x32_bf16 v[44:47], v[184:187], v[148:151], v[44:47]
    s_waitcnt lgkmcnt(7)
    v_mfma_f32_16x16x32_bf16 v[44:47], v[188:191], v[152:155], v[44:47]
    v_mfma_f32_16x16x32_bf16 v[48:51], v[184:187], v[152:155], v[48:51]
    s_waitcnt lgkmcnt(6)
    v_mfma_f32_16x16x32_bf16 v[48:51], v[188:191], v[156:159], v[48:51]
    s_waitcnt lgkmcnt(4)
    v_mfma_f32_16x16x32_bf16 v[20:23], v[176:179], v[132:135], v[20:23]
    ds_read_b64_tr_b16 v[184:185], v7 offset:64256
    s_waitcnt lgkmcnt(3)
    v_mfma_f32_16x16x32_bf16 v[20:23], v[180:183], v[136:139], v[20:23]
    ds_read_b64_tr_b16 v[186:187], v7 offset:64768
    v_mfma_f32_16x16x32_bf16 v[24:27], v[176:179], v[136:139], v[24:27]
    ds_read_b64_tr_b16 v[188:189], v8 offset:2816
    v_mfma_f32_16x16x32_bf16 v[24:27], v[180:183], v[140:143], v[24:27]
    ds_read_b64_tr_b16 v[190:191], v8 offset:3328
    v_mfma_f32_16x16x32_bf16 v[28:31], v[176:179], v[140:143], v[28:31]
    ds_read_b128 v[168:171], v195 offset:1696
    v_mfma_f32_16x16x32_bf16 v[28:31], v[180:183], v[144:147], v[28:31]
    ds_read_b128 v[172:175], v195 offset:1824
    v_mfma_f32_16x16x32_bf16 v[32:35], v[176:179], v[144:147], v[32:35]
    v_mfma_f32_16x16x32_bf16 v[32:35], v[180:183], v[148:151], v[32:35]
    v_mfma_f32_16x16x32_bf16 v[36:39], v[176:179], v[148:151], v[36:39]
    v_mfma_f32_16x16x32_bf16 v[36:39], v[180:183], v[152:155], v[36:39]
    v_mfma_f32_16x16x32_bf16 v[40:43], v[176:179], v[152:155], v[40:43]
    v_mfma_f32_16x16x32_bf16 v[40:43], v[180:183], v[156:159], v[40:43]
    v_mfma_f32_16x16x32_bf16 v[44:47], v[176:179], v[156:159], v[44:47]
    s_waitcnt lgkmcnt(7)
    v_mfma_f32_16x16x32_bf16 v[44:47], v[180:183], v[160:163], v[44:47]
    v_mfma_f32_16x16x32_bf16 v[48:51], v[176:179], v[160:163], v[48:51]
    s_waitcnt lgkmcnt(6)
    v_mfma_f32_16x16x32_bf16 v[48:51], v[180:183], v[164:167], v[48:51]
    s_waitcnt lgkmcnt(0)
    s_barrier
    v_mfma_f32_16x16x32_bf16 v[20:23], v[184:187], v[140:143], v[20:23]
    ds_read_b64_tr_b16 v[176:177], v8 offset:6912
    v_mfma_f32_16x16x32_bf16 v[20:23], v[188:191], v[144:147], v[20:23]
    ds_read_b64_tr_b16 v[178:179], v8 offset:7424
    v_mfma_f32_16x16x32_bf16 v[24:27], v[184:187], v[144:147], v[24:27]
    ds_read_b128 v[116:119], v195 offset:64
    v_mfma_f32_16x16x32_bf16 v[24:27], v[188:191], v[148:151], v[24:27]
    ds_read_b128 v[120:123], v195 offset:192
    v_mfma_f32_16x16x32_bf16 v[28:31], v[184:187], v[148:151], v[28:31]
    ds_read_b64_tr_b16 v[180:181], v8 offset:11008
    v_mfma_f32_16x16x32_bf16 v[28:31], v[188:191], v[152:155], v[28:31]
    ds_read_b64_tr_b16 v[182:183], v8 offset:11520
    v_mfma_f32_16x16x32_bf16 v[32:35], v[184:187], v[152:155], v[32:35]
    ds_read_b128 v[124:127], v195 offset:320
    v_mfma_f32_16x16x32_bf16 v[32:35], v[188:191], v[156:159], v[32:35]
    ds_read_b128 v[128:131], v195 offset:448
    v_mfma_f32_16x16x32_bf16 v[36:39], v[184:187], v[156:159], v[36:39]
    ds_read_b128 v[132:135], v195 offset:576
    v_mfma_f32_16x16x32_bf16 v[36:39], v[188:191], v[160:163], v[36:39]
    ds_read_b128 v[136:139], v195 offset:704
    v_mfma_f32_16x16x32_bf16 v[40:43], v[184:187], v[160:163], v[40:43]
    ds_read_b128 v[140:143], v195 offset:832
    v_mfma_f32_16x16x32_bf16 v[40:43], v[188:191], v[164:167], v[40:43]
    ds_read_b128 v[144:147], v195 offset:960
    v_mfma_f32_16x16x32_bf16 v[44:47], v[184:187], v[164:167], v[44:47]
    ds_read_b128 v[148:151], v195 offset:1120
    v_mfma_f32_16x16x32_bf16 v[44:47], v[188:191], v[168:171], v[44:47]
    v_mfma_f32_16x16x32_bf16 v[48:51], v[184:187], v[168:171], v[48:51]
    v_mfma_f32_16x16x32_bf16 v[48:51], v[188:191], v[172:175], v[48:51]
    s_waitcnt lgkmcnt(10)
    v_mfma_f32_16x16x32_bf16 v[20:23], v[176:179], v[116:119], v[20:23]
    ds_read_b64_tr_b16 v[184:185], v8 offset:15104
    s_waitcnt lgkmcnt(8)
    v_mfma_f32_16x16x32_bf16 v[20:23], v[180:183], v[120:123], v[20:23]
    ds_read_b64_tr_b16 v[186:187], v8 offset:15616
    v_mfma_f32_16x16x32_bf16 v[24:27], v[176:179], v[120:123], v[24:27]
    ds_read_b64_tr_b16 v[188:189], v8 offset:19200
    s_waitcnt lgkmcnt(9)
    v_mfma_f32_16x16x32_bf16 v[24:27], v[180:183], v[124:127], v[24:27]
    ds_read_b64_tr_b16 v[190:191], v8 offset:19712
    v_mfma_f32_16x16x32_bf16 v[28:31], v[176:179], v[124:127], v[28:31]
    ds_read_b128 v[152:155], v195 offset:1248
    s_waitcnt lgkmcnt(10)
    v_mfma_f32_16x16x32_bf16 v[28:31], v[180:183], v[128:131], v[28:31]
    ds_read_b128 v[156:159], v195 offset:1376
    v_mfma_f32_16x16x32_bf16 v[32:35], v[176:179], v[128:131], v[32:35]
    s_waitcnt lgkmcnt(10)
    v_mfma_f32_16x16x32_bf16 v[32:35], v[180:183], v[132:135], v[32:35]
    v_mfma_f32_16x16x32_bf16 v[36:39], v[176:179], v[132:135], v[36:39]
    s_waitcnt lgkmcnt(9)
    v_mfma_f32_16x16x32_bf16 v[36:39], v[180:183], v[136:139], v[36:39]
    v_mfma_f32_16x16x32_bf16 v[40:43], v[176:179], v[136:139], v[40:43]
    s_waitcnt lgkmcnt(8)
    v_mfma_f32_16x16x32_bf16 v[40:43], v[180:183], v[140:143], v[40:43]
    v_mfma_f32_16x16x32_bf16 v[44:47], v[176:179], v[140:143], v[44:47]
    s_waitcnt lgkmcnt(7)
    v_mfma_f32_16x16x32_bf16 v[44:47], v[180:183], v[144:147], v[44:47]
    v_mfma_f32_16x16x32_bf16 v[48:51], v[176:179], v[144:147], v[48:51]
    s_waitcnt lgkmcnt(6)
    v_mfma_f32_16x16x32_bf16 v[48:51], v[180:183], v[148:151], v[48:51]
    s_waitcnt lgkmcnt(4)
    v_mfma_f32_16x16x32_bf16 v[20:23], v[184:187], v[124:127], v[20:23]
    ds_read_b64_tr_b16 v[176:177], v8 offset:23296
    s_waitcnt lgkmcnt(3)
    v_mfma_f32_16x16x32_bf16 v[20:23], v[188:191], v[128:131], v[20:23]
    ds_read_b64_tr_b16 v[178:179], v8 offset:23808
    v_mfma_f32_16x16x32_bf16 v[24:27], v[184:187], v[128:131], v[24:27]
    ds_read_b64_tr_b16 v[180:181], v8 offset:27392
    v_mfma_f32_16x16x32_bf16 v[24:27], v[188:191], v[132:135], v[24:27]
    ds_read_b64_tr_b16 v[182:183], v8 offset:27904
    v_mfma_f32_16x16x32_bf16 v[28:31], v[184:187], v[132:135], v[28:31]
    ds_read_b128 v[160:163], v195 offset:1504
    v_mfma_f32_16x16x32_bf16 v[28:31], v[188:191], v[136:139], v[28:31]
    ds_read_b128 v[164:167], v195 offset:1632
    v_mfma_f32_16x16x32_bf16 v[32:35], v[184:187], v[136:139], v[32:35]
    v_mfma_f32_16x16x32_bf16 v[32:35], v[188:191], v[140:143], v[32:35]
    v_mfma_f32_16x16x32_bf16 v[36:39], v[184:187], v[140:143], v[36:39]
    v_mfma_f32_16x16x32_bf16 v[36:39], v[188:191], v[144:147], v[36:39]
    v_mfma_f32_16x16x32_bf16 v[40:43], v[184:187], v[144:147], v[40:43]
    v_mfma_f32_16x16x32_bf16 v[40:43], v[188:191], v[148:151], v[40:43]
    v_mfma_f32_16x16x32_bf16 v[44:47], v[184:187], v[148:151], v[44:47]
    s_waitcnt lgkmcnt(7)
    v_mfma_f32_16x16x32_bf16 v[44:47], v[188:191], v[152:155], v[44:47]
    v_mfma_f32_16x16x32_bf16 v[48:51], v[184:187], v[152:155], v[48:51]
    s_waitcnt lgkmcnt(6)
    v_mfma_f32_16x16x32_bf16 v[48:51], v[188:191], v[156:159], v[48:51]
    s_waitcnt lgkmcnt(4)
    v_mfma_f32_16x16x32_bf16 v[20:23], v[176:179], v[132:135], v[20:23]
    ds_read_b64_tr_b16 v[184:185], v8 offset:31488
    s_waitcnt lgkmcnt(3)
    v_mfma_f32_16x16x32_bf16 v[20:23], v[180:183], v[136:139], v[20:23]
    ds_read_b64_tr_b16 v[186:187], v8 offset:32000
    v_mfma_f32_16x16x32_bf16 v[24:27], v[176:179], v[136:139], v[24:27]
    ds_read_b64_tr_b16 v[188:189], v8 offset:35584
    v_mfma_f32_16x16x32_bf16 v[24:27], v[180:183], v[140:143], v[24:27]
    ds_read_b64_tr_b16 v[190:191], v8 offset:36096
    v_mfma_f32_16x16x32_bf16 v[28:31], v[176:179], v[140:143], v[28:31]
    ds_read_b128 v[168:171], v195 offset:1760
    v_mfma_f32_16x16x32_bf16 v[28:31], v[180:183], v[144:147], v[28:31]
    ds_read_b128 v[172:175], v195 offset:1888
    v_mfma_f32_16x16x32_bf16 v[32:35], v[176:179], v[144:147], v[32:35]
    v_mfma_f32_16x16x32_bf16 v[32:35], v[180:183], v[148:151], v[32:35]
    v_mfma_f32_16x16x32_bf16 v[36:39], v[176:179], v[148:151], v[36:39]
    v_mfma_f32_16x16x32_bf16 v[36:39], v[180:183], v[152:155], v[36:39]
    v_mfma_f32_16x16x32_bf16 v[40:43], v[176:179], v[152:155], v[40:43]
    v_mfma_f32_16x16x32_bf16 v[40:43], v[180:183], v[156:159], v[40:43]
    v_mfma_f32_16x16x32_bf16 v[44:47], v[176:179], v[156:159], v[44:47]
    s_waitcnt lgkmcnt(7)
    v_mfma_f32_16x16x32_bf16 v[44:47], v[180:183], v[160:163], v[44:47]
    v_mfma_f32_16x16x32_bf16 v[48:51], v[176:179], v[160:163], v[48:51]
    s_waitcnt lgkmcnt(6)
    v_mfma_f32_16x16x32_bf16 v[48:51], v[180:183], v[164:167], v[48:51]
    s_waitcnt lgkmcnt(0)
    s_barrier
    v_mfma_f32_16x16x32_bf16 v[20:23], v[184:187], v[140:143], v[20:23]
    ds_read_b64_tr_b16 v[176:177], v8 offset:39680
    v_mfma_f32_16x16x32_bf16 v[20:23], v[188:191], v[144:147], v[20:23]
    ds_read_b64_tr_b16 v[178:179], v8 offset:40192
    v_mfma_f32_16x16x32_bf16 v[24:27], v[184:187], v[144:147], v[24:27]
    ds_read_b128 v[116:119], v195 offset:17792
    v_mfma_f32_16x16x32_bf16 v[24:27], v[188:191], v[148:151], v[24:27]
    ds_read_b128 v[120:123], v195 offset:17920
    v_mfma_f32_16x16x32_bf16 v[28:31], v[184:187], v[148:151], v[28:31]
    ds_read_b128 v[124:127], v195 offset:18048
    v_mfma_f32_16x16x32_bf16 v[28:31], v[188:191], v[152:155], v[28:31]
    ds_read_b128 v[128:131], v195 offset:18176
    v_mfma_f32_16x16x32_bf16 v[32:35], v[184:187], v[152:155], v[32:35]
    ds_read_b128 v[132:135], v195 offset:18304
    v_mfma_f32_16x16x32_bf16 v[32:35], v[188:191], v[156:159], v[32:35]
    ds_read_b128 v[136:139], v195 offset:18432
    v_mfma_f32_16x16x32_bf16 v[36:39], v[184:187], v[156:159], v[36:39]
    ds_read_b128 v[140:143], v195 offset:18560
    v_mfma_f32_16x16x32_bf16 v[36:39], v[188:191], v[160:163], v[36:39]
    ds_read_b128 v[144:147], v195 offset:18688
    v_mfma_f32_16x16x32_bf16 v[40:43], v[184:187], v[160:163], v[40:43]
    ds_read_b128 v[148:151], v195 offset:18848
    v_mfma_f32_16x16x32_bf16 v[40:43], v[188:191], v[164:167], v[40:43]
    v_mfma_f32_16x16x32_bf16 v[44:47], v[184:187], v[164:167], v[44:47]
    v_mfma_f32_16x16x32_bf16 v[44:47], v[188:191], v[168:171], v[44:47]
    v_mfma_f32_16x16x32_bf16 v[48:51], v[184:187], v[168:171], v[48:51]
    v_mfma_f32_16x16x32_bf16 v[48:51], v[188:191], v[172:175], v[48:51]
    s_waitcnt lgkmcnt(8)
    v_mfma_f32_16x16x32_bf16 v[52:55], v[176:179], v[116:119], v[52:55]
    ds_read_b64_tr_b16 v[184:185], v8 offset:43776
    s_waitcnt lgkmcnt(8)
    v_mfma_f32_16x16x32_bf16 v[56:59], v[176:179], v[120:123], v[56:59]
    ds_read_b64_tr_b16 v[186:187], v8 offset:44288
    s_waitcnt lgkmcnt(8)
    v_mfma_f32_16x16x32_bf16 v[60:63], v[176:179], v[124:127], v[60:63]
    ds_read_b64_tr_b16 v[188:189], v8 offset:47872
    s_waitcnt lgkmcnt(8)
    v_mfma_f32_16x16x32_bf16 v[64:67], v[176:179], v[128:131], v[64:67]
    ds_read_b64_tr_b16 v[190:191], v8 offset:48384
    s_waitcnt lgkmcnt(8)
    v_mfma_f32_16x16x32_bf16 v[68:71], v[176:179], v[132:135], v[68:71]
    ds_read_b128 v[152:155], v195 offset:18976
    s_waitcnt lgkmcnt(8)
    v_mfma_f32_16x16x32_bf16 v[72:75], v[176:179], v[136:139], v[72:75]
    s_waitcnt lgkmcnt(7)
    v_mfma_f32_16x16x32_bf16 v[76:79], v[176:179], v[140:143], v[76:79]
    s_waitcnt lgkmcnt(6)
    v_mfma_f32_16x16x32_bf16 v[80:83], v[176:179], v[144:147], v[80:83]
    s_waitcnt lgkmcnt(3)
    v_mfma_f32_16x16x32_bf16 v[52:55], v[184:187], v[120:123], v[52:55]
    ds_read_b64_tr_b16 v[176:177], v8 offset:51968
    s_waitcnt lgkmcnt(2)
    v_mfma_f32_16x16x32_bf16 v[52:55], v[188:191], v[124:127], v[52:55]
    ds_read_b64_tr_b16 v[178:179], v8 offset:52480
    v_mfma_f32_16x16x32_bf16 v[56:59], v[184:187], v[124:127], v[56:59]
    ds_read_b64_tr_b16 v[180:181], v8 offset:56064
    v_mfma_f32_16x16x32_bf16 v[56:59], v[188:191], v[128:131], v[56:59]
    ds_read_b64_tr_b16 v[182:183], v8 offset:56576
    v_mfma_f32_16x16x32_bf16 v[60:63], v[184:187], v[128:131], v[60:63]
    ds_read_b128 v[156:159], v195 offset:19104
    v_mfma_f32_16x16x32_bf16 v[60:63], v[188:191], v[132:135], v[60:63]
    ds_read_b128 v[160:163], v195 offset:19232
    v_mfma_f32_16x16x32_bf16 v[64:67], v[184:187], v[132:135], v[64:67]
    v_mfma_f32_16x16x32_bf16 v[64:67], v[188:191], v[136:139], v[64:67]
    v_mfma_f32_16x16x32_bf16 v[68:71], v[184:187], v[136:139], v[68:71]
    v_mfma_f32_16x16x32_bf16 v[68:71], v[188:191], v[140:143], v[68:71]
    v_mfma_f32_16x16x32_bf16 v[72:75], v[184:187], v[140:143], v[72:75]
    v_mfma_f32_16x16x32_bf16 v[72:75], v[188:191], v[144:147], v[72:75]
    v_mfma_f32_16x16x32_bf16 v[76:79], v[184:187], v[144:147], v[76:79]
    v_mfma_f32_16x16x32_bf16 v[76:79], v[188:191], v[148:151], v[76:79]
    v_mfma_f32_16x16x32_bf16 v[80:83], v[184:187], v[148:151], v[80:83]
    s_waitcnt lgkmcnt(6)
    v_mfma_f32_16x16x32_bf16 v[80:83], v[188:191], v[152:155], v[80:83]
    s_waitcnt lgkmcnt(4)
    v_mfma_f32_16x16x32_bf16 v[52:55], v[176:179], v[128:131], v[52:55]
    ds_read_b64_tr_b16 v[184:185], v8 offset:60160
    s_waitcnt lgkmcnt(3)
    v_mfma_f32_16x16x32_bf16 v[52:55], v[180:183], v[132:135], v[52:55]
    ds_read_b64_tr_b16 v[186:187], v8 offset:60672
    v_mfma_f32_16x16x32_bf16 v[56:59], v[176:179], v[132:135], v[56:59]
    ds_read_b64_tr_b16 v[188:189], v8 offset:64256
    v_mfma_f32_16x16x32_bf16 v[56:59], v[180:183], v[136:139], v[56:59]
    ds_read_b64_tr_b16 v[190:191], v8 offset:64768
    v_mfma_f32_16x16x32_bf16 v[60:63], v[176:179], v[136:139], v[60:63]
    ds_read_b128 v[164:167], v195 offset:19360
    v_mfma_f32_16x16x32_bf16 v[60:63], v[180:183], v[140:143], v[60:63]
    ds_read_b128 v[168:171], v195 offset:19488
    v_mfma_f32_16x16x32_bf16 v[64:67], v[176:179], v[140:143], v[64:67]
    v_mfma_f32_16x16x32_bf16 v[64:67], v[180:183], v[144:147], v[64:67]
    v_mfma_f32_16x16x32_bf16 v[68:71], v[176:179], v[144:147], v[68:71]
    v_mfma_f32_16x16x32_bf16 v[68:71], v[180:183], v[148:151], v[68:71]
    v_mfma_f32_16x16x32_bf16 v[72:75], v[176:179], v[148:151], v[72:75]
    v_mfma_f32_16x16x32_bf16 v[72:75], v[180:183], v[152:155], v[72:75]
    v_mfma_f32_16x16x32_bf16 v[76:79], v[176:179], v[152:155], v[76:79]
    s_waitcnt lgkmcnt(7)
    v_mfma_f32_16x16x32_bf16 v[76:79], v[180:183], v[156:159], v[76:79]
    v_mfma_f32_16x16x32_bf16 v[80:83], v[176:179], v[156:159], v[80:83]
    s_waitcnt lgkmcnt(6)
    v_mfma_f32_16x16x32_bf16 v[80:83], v[180:183], v[160:163], v[80:83]
    s_waitcnt lgkmcnt(0)
    s_barrier
    v_mfma_f32_16x16x32_bf16 v[52:55], v[184:187], v[136:139], v[52:55]
    ds_read_b64_tr_b16 v[176:177], v9 offset:2816
    v_mfma_f32_16x16x32_bf16 v[52:55], v[188:191], v[140:143], v[52:55]
    ds_read_b64_tr_b16 v[178:179], v9 offset:3328
    v_mfma_f32_16x16x32_bf16 v[56:59], v[184:187], v[140:143], v[56:59]
    ds_read_b128 v[116:119], v195 offset:17856
    v_mfma_f32_16x16x32_bf16 v[56:59], v[188:191], v[144:147], v[56:59]
    ds_read_b128 v[120:123], v195 offset:17984
    v_mfma_f32_16x16x32_bf16 v[60:63], v[184:187], v[144:147], v[60:63]
    ds_read_b128 v[124:127], v195 offset:18112
    v_mfma_f32_16x16x32_bf16 v[60:63], v[188:191], v[148:151], v[60:63]
    ds_read_b128 v[128:131], v195 offset:18240
    v_mfma_f32_16x16x32_bf16 v[64:67], v[184:187], v[148:151], v[64:67]
    ds_read_b128 v[132:135], v195 offset:18368
    v_mfma_f32_16x16x32_bf16 v[64:67], v[188:191], v[152:155], v[64:67]
    ds_read_b128 v[136:139], v195 offset:18496
    v_mfma_f32_16x16x32_bf16 v[68:71], v[184:187], v[152:155], v[68:71]
    ds_read_b128 v[140:143], v195 offset:18624
    v_mfma_f32_16x16x32_bf16 v[68:71], v[188:191], v[156:159], v[68:71]
    ds_read_b128 v[144:147], v195 offset:18752
    v_mfma_f32_16x16x32_bf16 v[72:75], v[184:187], v[156:159], v[72:75]
    ds_read_b128 v[148:151], v195 offset:18912
    v_mfma_f32_16x16x32_bf16 v[72:75], v[188:191], v[160:163], v[72:75]
    v_mfma_f32_16x16x32_bf16 v[76:79], v[184:187], v[160:163], v[76:79]
    v_mfma_f32_16x16x32_bf16 v[76:79], v[188:191], v[164:167], v[76:79]
    v_mfma_f32_16x16x32_bf16 v[80:83], v[184:187], v[164:167], v[80:83]
    v_mfma_f32_16x16x32_bf16 v[80:83], v[188:191], v[168:171], v[80:83]
    s_cmp_eq_u32 s54, 3
    s_cbranch_scc1 L_p1_last
    s_waitcnt lgkmcnt(8)
    v_mfma_f32_16x16x32_bf16 v[52:55], v[176:179], v[116:119], v[52:55]
    ds_read_b64_tr_b16 v[184:185], v9 offset:6912
    s_waitcnt lgkmcnt(8)
    v_mfma_f32_16x16x32_bf16 v[56:59], v[176:179], v[120:123], v[56:59]
    ds_read_b64_tr_b16 v[186:187], v9 offset:7424
    s_waitcnt lgkmcnt(8)
    v_mfma_f32_16x16x32_bf16 v[60:63], v[176:179], v[124:127], v[60:63]
    ds_read_b64_tr_b16 v[188:189], v9 offset:11008
    s_waitcnt lgkmcnt(8)
    v_mfma_f32_16x16x32_bf16 v[64:67], v[176:179], v[128:131], v[64:67]
    ds_read_b64_tr_b16 v[190:191], v9 offset:11520
    s_waitcnt lgkmcnt(8)
    v_mfma_f32_16x16x32_bf16 v[68:71], v[176:179], v[132:135], v[68:71]
    ds_read_b128 v[152:155], v195 offset:19040
    s_waitcnt lgkmcnt(8)
    v_mfma_f32_16x16x32_bf16 v[72:75], v[176:179], v[136:139], v[72:75]
    s_waitcnt lgkmcnt(7)
    v_mfma_f32_16x16x32_bf16 v[76:79], v[176:179], v[140:143], v[76:79]
    s_waitcnt lgkmcnt(6)
    v_mfma_f32_16x16x32_bf16 v[80:83], v[176:179], v[144:147], v[80:83]
    s_waitcnt lgkmcnt(3)
    v_mfma_f32_16x16x32_bf16 v[52:55], v[184:187], v[120:123], v[52:55]
    ds_read_b64_tr_b16 v[176:177], v9 offset:15104
    s_waitcnt lgkmcnt(2)
    v_mfma_f32_16x16x32_bf16 v[52:55], v[188:191], v[124:127], v[52:55]
    ds_read_b64_tr_b16 v[178:179], v9 offset:15616
    v_mfma_f32_16x16x32_bf16 v[56:59], v[184:187], v[124:127], v[56:59]
    ds_read_b64_tr_b16 v[180:181], v9 offset:19200
    v_mfma_f32_16x16x32_bf16 v[56:59], v[188:191], v[128:131], v[56:59]
    ds_read_b64_tr_b16 v[182:183], v9 offset:19712
    v_mfma_f32_16x16x32_bf16 v[60:63], v[184:187], v[128:131], v[60:63]
    ds_read_b128 v[156:159], v195 offset:19168
    v_mfma_f32_16x16x32_bf16 v[60:63], v[188:191], v[132:135], v[60:63]
    ds_read_b128 v[160:163], v195 offset:19296
    v_mfma_f32_16x16x32_bf16 v[64:67], v[184:187], v[132:135], v[64:67]
    v_mfma_f32_16x16x32_bf16 v[64:67], v[188:191], v[136:139], v[64:67]
    v_mfma_f32_16x16x32_bf16 v[68:71], v[184:187], v[136:139], v[68:71]
    v_mfma_f32_16x16x32_bf16 v[68:71], v[188:191], v[140:143], v[68:71]
    v_mfma_f32_16x16x32_bf16 v[72:75], v[184:187], v[140:143], v[72:75]
    v_mfma_f32_16x16x32_bf16 v[72:75], v[188:191], v[144:147], v[72:75]
    v_mfma_f32_16x16x32_bf16 v[76:79], v[184:187], v[144:147], v[76:79]
    v_mfma_f32_16x16x32_bf16 v[76:79], v[188:191], v[148:151], v[76:79]
    v_mfma_f32_16x16x32_bf16 v[80:83], v[184:187], v[148:151], v[80:83]
    s_waitcnt lgkmcnt(6)
    v_mfma_f32_16x16x32_bf16 v[80:83], v[188:191], v[152:155], v[80:83]
    s_waitcnt lgkmcnt(4)
    v_mfma_f32_16x16x32_bf16 v[52:55], v[176:179], v[128:131], v[52:55]
    ds_read_b64_tr_b16 v[184:185], v9 offset:23296
    s_waitcnt lgkmcnt(3)
    v_mfma_f32_16x16x32_bf16 v[52:55], v[180:183], v[132:135], v[52:55]
    ds_read_b64_tr_b16 v[186:187], v9 offset:23808
    v_mfma_f32_16x16x32_bf16 v[56:59], v[176:179], v[132:135], v[56:59]
    ds_read_b64_tr_b16 v[188:189], v9 offset:27392
    v_mfma_f32_16x16x32_bf16 v[56:59], v[180:183], v[136:139], v[56:59]
    ds_read_b64_tr_b16 v[190:191], v9 offset:27904
    v_mfma_f32_16x16x32_bf16 v[60:63], v[176:179], v[136:139], v[60:63]
    ds_read_b128 v[164:167], v195 offset:19424
    v_mfma_f32_16x16x32_bf16 v[60:63], v[180:183], v[140:143], v[60:63]
    ds_read_b128 v[168:171], v195 offset:19552
    v_mfma_f32_16x16x32_bf16 v[64:67], v[176:179], v[140:143], v[64:67]
    v_mfma_f32_16x16x32_bf16 v[64:67], v[180:183], v[144:147], v[64:67]
    v_mfma_f32_16x16x32_bf16 v[68:71], v[176:179], v[144:147], v[68:71]
    v_mfma_f32_16x16x32_bf16 v[68:71], v[180:183], v[148:151], v[68:71]
    v_mfma_f32_16x16x32_bf16 v[72:75], v[176:179], v[148:151], v[72:75]
    v_mfma_f32_16x16x32_bf16 v[72:75], v[180:183], v[152:155], v[72:75]
    v_mfma_f32_16x16x32_bf16 v[76:79], v[176:179], v[152:155], v[76:79]
    s_waitcnt lgkmcnt(7)
    v_mfma_f32_16x16x32_bf16 v[76:79], v[180:183], v[156:159], v[76:79]
    v_mfma_f32_16x16x32_bf16 v[80:83], v[176:179], v[156:159], v[80:83]
    s_waitcnt lgkmcnt(6)
    v_mfma_f32_16x16x32_bf16 v[80:83], v[180:183], v[160:163], v[80:83]
    s_waitcnt lgkmcnt(0)
    s_barrier
    v_mfma_f32_16x16x32_bf16 v[52:55], v[184:187], v[136:139], v[52:55]
    ds_read_b64_tr_b16 v[176:177], v7 offset:35584
    v_mfma_f32_16x16x32_bf16 v[52:55], v[188:191], v[140:143], v[52:55]
    ds_read_b64_tr_b16 v[178:179], v7 offset:36096
    v_mfma_f32_16x16x32_bf16 v[56:59], v[184:187], v[140:143], v[56:59]
    ds_read_b128 v[116:119], v195 offset:0
    v_mfma_f32_16x16x32_bf16 v[56:59], v[188:191], v[144:147], v[56:59]
    ds_read_b128 v[120:123], v195 offset:128
    v_mfma_f32_16x16x32_bf16 v[60:63], v[184:187], v[144:147], v[60:63]
    ds_read_b64_tr_b16 v[180:181], v7 offset:39680
    v_mfma_f32_16x16x32_bf16 v[60:63], v[188:191], v[148:151], v[60:63]
    ds_read_b64_tr_b16 v[182:183], v7 offset:40192
    v_mfma_f32_16x16x32_bf16 v[64:67], v[184:187], v[148:151], v[64:67]
    ds_read_b128 v[124:127], v195 offset:256
    v_mfma_f32_16x16x32_bf16 v[64:67], v[188:191], v[152:155], v[64:67]
    ds_read_b128 v[128:131], v195 offset:384
    v_mfma_f32_16x16x32_bf16 v[68:71], v[184:187], v[152:155], v[68:71]
    ds_read_b128 v[132:135], v195 offset:512
    v_mfma_f32_16x16x32_bf16 v[68:71], v[188:191], v[156:159], v[68:71]
    ds_read_b128 v[136:139], v195 offset:640
    v_mfma_f32_16x16x32_bf16 v[72:75], v[184:187], v[156:159], v[72:75]
    ds_read_b128 v[140:143], v195 offset:768
    v_mfma_f32_16x16x32_bf16 v[72:75], v[188:191], v[160:163], v[72:75]
    ds_read_b128 v[144:147], v195 offset:896
    v_mfma_f32_16x16x32_bf16 v[76:79], v[184:187], v[160:163], v[76:79]
    ds_read_b128 v[148:151], v195 offset:1056
    v_mfma_f32_16x16x32_bf16 v[76:79], v[188:191], v[164:167], v[76:79]
    v_mfma_f32_16x16x32_bf16 v[80:83], v[184:187], v[164:167], v[80:83]
    v_mfma_f32_16x16x32_bf16 v[80:83], v[188:191], v[168:171], v[80:83]
    s_cmp_lg_u32 s54, 0
    s_cbranch_scc1 L_nodr
    s_waitcnt vmcnt(0)
L_nodr:
    s_add_u32 s54, s54, 1
    s_branch L_p1
L_p1_last:
    s_waitcnt lgkmcnt(8)
    v_mfma_f32_16x16x32_bf16 v[52:55], v[176:179], v[116:119], v[52:55]
    ds_read_b64_tr_b16 v[184:185], v9 offset:6912
    s_waitcnt lgkmcnt(8)
    v_mfma_f32_16x16x32_bf16 v[56:59], v[176:179], v[120:123], v[56:59]
    ds_read_b64_tr_b16 v[186:187], v9 offset:7424
    s_waitcnt lgkmcnt(8)
    v_mfma_f32_16x16x32_bf16 v[60:63], v[176:179], v[124:127], v[60:63]
    ds_read_b64_tr_b16 v[188:189], v9 offset:11008
    s_waitcnt lgkmcnt(8)
    v_mfma_f32_16x16x32_bf16 v[64:67], v[176:179], v[128:131], v[64:67]
    ds_read_b64_tr_b16 v[190:191], v9 offset:11520
    s_waitcnt lgkmcnt(8)
    v_mfma_f32_16x16x32_bf16 v[68:71], v[176:179], v[132:135], v[68:71]
    ds_read_b128 v[152:155], v195 offset:19040
    s_waitcnt lgkmcnt(8)
    v_mfma_f32_16x16x32_bf16 v[72:75], v[176:179], v[136:139], v[72:75]
    s_waitcnt lgkmcnt(7)
    v_mfma_f32_16x16x32_bf16 v[76:79], v[176:179], v[140:143], v[76:79]
    s_waitcnt lgkmcnt(6)
    v_mfma_f32_16x16x32_bf16 v[80:83], v[176:179], v[144:147], v[80:83]
    s_waitcnt lgkmcnt(3)
    v_mfma_f32_16x16x32_bf16 v[52:55], v[184:187], v[120:123], v[52:55]
    ds_read_b64_tr_b16 v[176:177], v9 offset:15104
    s_waitcnt lgkmcnt(2)
    v_mfma_f32_16x16x32_bf16 v[52:55], v[188:191], v[124:127], v[52:55]
    ds_read_b64_tr_b16 v[178:179], v9 offset:15616
    v_mfma_f32_16x16x32_bf16 v[56:59], v[184:187], v[124:127], v[56:59]
    ds_read_b64_tr_b16 v[180:181], v9 offset:19200
    v_mfma_f32_16x16x32_bf16 v[56:59], v[188:191], v[128:131], v[56:59]
    ds_read_b64_tr_b16 v[182:183], v9 offset:19712
    v_mfma_f32_16x16x32_bf16 v[60:63], v[184:187], v[128:131], v[60:63]
    ds_read_b128 v[156:159], v195 offset:19168
    v_mfma_f32_16x16x32_bf16 v[60:63], v[188:191], v[132:135], v[60:63]
    ds_read_b128 v[160:163], v195 offset:19296
    v_mfma_f32_16x16x32_bf16 v[64:67], v[184:187], v[132:135], v[64:67]
    v_mfma_f32_16x16x32_bf16 v[64:67], v[188:191], v[136:139], v[64:67]
    v_mfma_f32_16x16x32_bf16 v[68:71], v[184:187], v[136:139], v[68:71]
    v_mfma_f32_16x16x32_bf16 v[68:71], v[188:191], v[140:143], v[68:71]
    v_mfma_f32_16x16x32_bf16 v[72:75], v[184:187], v[140:143], v[72:75]
    v_mfma_f32_16x16x32_bf16 v[72:75], v[188:191], v[144:147], v[72:75]
    v_mfma_f32_16x16x32_bf16 v[76:79], v[184:187], v[144:147], v[76:79]
    v_mfma_f32_16x16x32_bf16 v[76:79], v[188:191], v[148:151], v[76:79]
    v_mfma_f32_16x16x32_bf16 v[80:83], v[184:187], v[148:151], v[80:83]
    s_waitcnt lgkmcnt(6)
    v_mfma_f32_16x16x32_bf16 v[80:83], v[188:191], v[152:155], v[80:83]
    s_waitcnt lgkmcnt(4)
    v_mfma_f32_16x16x32_bf16 v[52:55], v[176:179], v[128:131], v[52:55]
    ds_read_b64_tr_b16 v[184:185], v9 offset:23296
    s_waitcnt lgkmcnt(3)
    v_mfma_f32_16x16x32_bf16 v[52:55], v[180:183], v[132:135], v[52:55]
    ds_read_b64_tr_b16 v[186:187], v9 offset:23808
    v_mfma_f32_16x16x32_bf16 v[56:59], v[176:179], v[132:135], v[56:59]
    ds_read_b64_tr_b16 v[188:189], v9 offset:27392
    v_mfma_f32_16x16x32_bf16 v[56:59], v[180:183], v[136:139], v[56:59]
    ds_read_b64_tr_b16 v[190:191], v9 offset:27904
    v_mfma_f32_16x16x32_bf16 v[60:63], v[176:179], v[136:139], v[60:63]
    ds_read_b128 v[164:167], v195 offset:19424
    v_mfma_f32_16x16x32_bf16 v[60:63], v[180:183], v[140:143], v[60:63]
    ds_read_b128 v[168:171], v195 offset:19552
    v_mfma_f32_16x16x32_bf16 v[64:67], v[176:179], v[140:143], v[64:67]
    v_mfma_f32_16x16x32_bf16 v[64:67], v[180:183], v[144:147], v[64:67]
    v_mfma_f32_16x16x32_bf16 v[68:71], v[176:179], v[144:147], v[68:71]
    v_mfma_f32_16x16x32_bf16 v[68:71], v[180:183], v[148:151], v[68:71]
    v_mfma_f32_16x16x32_bf16 v[72:75], v[176:179], v[148:151], v[72:75]
    v_mfma_f32_16x16x32_bf16 v[72:75], v[180:183], v[152:155], v[72:75]
    v_mfma_f32_16x16x32_bf16 v[76:79], v[176:179], v[152:155], v[76:79]
    s_waitcnt lgkmcnt(7)
    v_mfma_f32_16x16x32_bf16 v[76:79], v[180:183], v[156:159], v[76:79]
    v_mfma_f32_16x16x32_bf16 v[80:83], v[176:179], v[156:159], v[80:83]
    s_waitcnt lgkmcnt(6)
    v_mfma_f32_16x16x32_bf16 v[80:83], v[180:183], v[160:163], v[80:83]
    s_waitcnt lgkmcnt(0)
    s_barrier
    v_mfma_f32_16x16x32_bf16 v[52:55], v[184:187], v[136:139], v[52:55]
    ds_read_b64_tr_b16 v[176:177], v7 offset:35584
    v_mfma_f32_16x16x32_bf16 v[52:55], v[188:191], v[140:143], v[52:55]
    ds_read_b64_tr_b16 v[178:179], v7 offset:36096
    v_mfma_f32_16x16x32_bf16 v[56:59], v[184:187], v[140:143], v[56:59]
    ds_read_b128 v[116:119], v3 offset:0
    v_mfma_f32_16x16x32_bf16 v[56:59], v[188:191], v[144:147], v[56:59]
    ds_read_b128 v[120:123], v3 offset:64
    v_mfma_f32_16x16x32_bf16 v[60:63], v[184:187], v[144:147], v[60:63]
    ds_read_b64_tr_b16 v[180:181], v7 offset:39680
    v_mfma_f32_16x16x32_bf16 v[60:63], v[188:191], v[148:151], v[60:63]
    ds_read_b64_tr_b16 v[182:183], v7 offset:40192
    v_mfma_f32_16x16x32_bf16 v[64:67], v[184:187], v[148:151], v[64:67]
    ds_read_b128 v[124:127], v3 offset:128
    v_mfma_f32_16x16x32_bf16 v[64:67], v[188:191], v[152:155], v[64:67]
    ds_read_b128 v[128:131], v3 offset:192
    v_mfma_f32_16x16x32_bf16 v[68:71], v[184:187], v[152:155], v[68:71]
    ds_read_b128 v[132:135], v3 offset:256
    v_mfma_f32_16x16x32_bf16 v[68:71], v[188:191], v[156:159], v[68:71]
    ds_read_b128 v[136:139], v3 offset:320
    v_mfma_f32_16x16x32_bf16 v[72:75], v[184:187], v[156:159], v[72:75]
    ds_read_b128 v[140:143], v3 offset:384
    v_mfma_f32_16x16x32_bf16 v[72:75], v[188:191], v[160:163], v[72:75]
    ds_read_b128 v[144:147], v3 offset:448
    v_mfma_f32_16x16x32_bf16 v[76:79], v[184:187], v[160:163], v[76:79]
    ds_read_b128 v[148:151], v4 offset:0
    v_mfma_f32_16x16x32_bf16 v[76:79], v[188:191], v[164:167], v[76:79]
    v_mfma_f32_16x16x32_bf16 v[80:83], v[184:187], v[164:167], v[80:83]
    v_mfma_f32_16x16x32_bf16 v[80:83], v[188:191], v[168:171], v[80:83]
    v_mov_b32_dpp v196, v20 row_shl:1 row_mask:0xf bank_mask:0xf bound_ctrl:0
    v_mov_b32_dpp v197, v21 row_shl:1 row_mask:0xf bank_mask:0xf bound_ctrl:0
    v_mov_b32_dpp v198, v22 row_shl:1 row_mask:0xf bank_mask:0xf bound_ctrl:0
    v_mov_b32_dpp v199, v23 row_shl:1 row_mask:0xf bank_mask:0xf bound_ctrl:0
    s_nop 3
    v_pk_add_f32 v[84:85], v[52:53], v[24:25]
    v_pk_add_f32 v[86:87], v[54:55], v[26:27]
    v_pk_add_f32 v[20:21], v[20:21], v[52:53]
    v_pk_add_f32 v[22:23], v[22:23], v[54:55]
    v_pk_add_f32 v[88:89], v[56:57], v[28:29]
    v_pk_add_f32 v[90:91], v[58:59], v[30:31]
    v_pk_add_f32 v[24:25], v[24:25], v[56:57]
    v_pk_add_f32 v[26:27], v[26:27], v[58:59]
    v_pk_add_f32 v[92:93], v[60:61], v[32:33]
    v_pk_add_f32 v[94:95], v[62:63], v[34:35]
    v_pk_add_f32 v[28:29], v[28:29], v[60:61]
    v_pk_add_f32 v[30:31], v[30:31], v[62:63]
    v_pk_add_f32 v[96:97], v[64:65], v[36:37]
    v_pk_add_f32 v[98:99], v[66:67], v[38:39]
    v_pk_add_f32 v[32:33], v[32:33], v[64:65]
    v_pk_add_f32 v[34:35], v[34:35], v[66:67]
    v_pk_add_f32 v[100:101], v[68:69], v[40:41]
    v_pk_add_f32 v[102:103], v[70:71], v[42:43]
    v_pk_add_f32 v[36:37], v[36:37], v[68:69]
    v_pk_add_f32 v[38:39], v[38:39], v[70:71]
    v_pk_add_f32 v[104:105], v[72:73], v[44:45]
    v_pk_add_f32 v[106:107], v[74:75], v[46:47]
    v_pk_add_f32 v[40:41], v[40:41], v[72:73]
    v_pk_add_f32 v[42:43], v[42:43], v[74:75]
    v_pk_add_f32 v[108:109], v[76:77], v[48:49]
    v_pk_add_f32 v[110:111], v[78:79], v[50:51]
    v_pk_add_f32 v[44:45], v[44:45], v[76:77]
    v_pk_add_f32 v[46:47], v[46:47], v[78:79]
    v_pk_add_f32 v[112:113], v[80:81], v[196:197]
    v_pk_add_f32 v[114:115], v[82:83], v[198:199]
    v_pk_add_f32 v[48:49], v[48:49], v[80:81]
    v_pk_add_f32 v[50:51], v[50:51], v[82:83]
    v_mov_b32_dpp v60, v20 row_newbcast:0 row_mask:0xf bank_mask:0xf
    v_mov_b32_dpp v61, v21 row_newbcast:0 row_mask:0xf bank_mask:0xf
    v_mov_b32_dpp v62, v22 row_newbcast:0 row_mask:0xf bank_mask:0xf
    v_mov_b32_dpp v63, v23 row_newbcast:0 row_mask:0xf bank_mask:0xf
    s_mov_b32 s54, 0
    s_waitcnt lgkmcnt(10)
    v_mfma_f32_16x16x32_bf16 v[84:87], v[176:179], v[116:119], v[84:87]
    ds_read_b64_tr_b16 v[184:185], v7 offset:43776
    v_mov_b32 v52, 0
    s_waitcnt lgkmcnt(8)
    v_mfma_f32_16x16x32_bf16 v[84:87], v[180:183], v[120:123], v[84:87]
    ds_read_b64_tr_b16 v[186:187], v7 offset:44288
    v_mov_b32 v53, 0
    v_mfma_f32_16x16x32_bf16 v[88:91], v[176:179], v[120:123], v[88:91]
    ds_read_b64_tr_b16 v[188:189], v7 offset:47872
    v_mov_b32 v54, 0
    s_waitcnt lgkmcnt(9)
    v_mfma_f32_16x16x32_bf16 v[88:91], v[180:183], v[124:127], v[88:91]
    ds_read_b64_tr_b16 v[190:191], v7 offset:48384
    v_mov_b32 v55, 0
    v_mfma_f32_16x16x32_bf16 v[92:95], v[176:179], v[124:127], v[92:95]
    ds_read_b128 v[152:155], v4 offset:64
    v_mov_b32 v56, 0
    s_waitcnt lgkmcnt(10)
    v_mfma_f32_16x16x32_bf16 v[92:95], v[180:183], v[128:131], v[92:95]
    ds_read_b128 v[156:159], v4 offset:128
    v_mov_b32 v57, 0
    v_mfma_f32_16x16x32_bf16 v[96:99], v[176:179], v[128:131], v[96:99]
    v_mov_b32 v58, 0
    v_mov_b32 v59, 0
    s_waitcnt lgkmcnt(10)
    v_mfma_f32_16x16x32_bf16 v[96:99], v[180:183], v[132:135], v[96:99]
    v_sub_f32 v64, v20, v60
    v_sub_f32 v65, v21, v61
    v_mfma_f32_16x16x32_bf16 v[100:103], v[176:179], v[132:135], v[100:103]
    v_sub_f32 v66, v22, v62
    v_sub_f32 v67, v23, v63
    s_waitcnt lgkmcnt(9)
    v_mfma_f32_16x16x32_bf16 v[100:103], v[180:183], v[136:139], v[100:103]
    v_add_f32 v52, v52, v64
    v_add_f32 v53, v53, v65
    v_mfma_f32_16x16x32_bf16 v[104:107], v[176:179], v[136:139], v[104:107]
    v_add_f32 v54, v54, v66
    v_add_f32 v55, v55, v67
    s_waitcnt lgkmcnt(8)
    v_mfma_f32_16x16x32_bf16 v[104:107], v[180:183], v[140:143], v[104:107]
    v_fmac_f32 v56, v64, v64
    v_fmac_f32 v57, v65, v65
    v_mfma_f32_16x16x32_bf16 v[108:111], v[176:179], v[140:143], v[108:111]
    v_fmac_f32 v58, v66, v66
    v_fmac_f32 v59, v67, v67
    s_waitcnt lgkmcnt(7)
    v_mfma_f32_16x16x32_bf16 v[108:111], v[180:183], v[144:147], v[108:111]
    v_sub_f32 v68, v24, v60
    v_sub_f32 v69, v25, v61
    v_mfma_f32_16x16x32_bf16 v[112:115], v[176:179], v[144:147], v[112:115]
    v_sub_f32 v70, v26, v62
    v_sub_f32 v71, v27, v63
    s_waitcnt lgkmcnt(6)
    v_mfma_f32_16x16x32_bf16 v[112:115], v[180:183], v[148:151], v[112:115]
    v_add_f32 v52, v52, v68
    v_add_f32 v53, v53, v69
    s_waitcnt lgkmcnt(4)
    v_mfma_f32_16x16x32_bf16 v[84:87], v[184:187], v[124:127], v[84:87]
    ds_read_b64_tr_b16 v[176:177], v7 offset:51968
    v_add_f32 v54, v54, v70
    s_waitcnt lgkmcnt(3)
    v_mfma_f32_16x16x32_bf16 v[84:87], v[188:191], v[128:131], v[84:87]
    ds_read_b64_tr_b16 v[178:179], v7 offset:52480
    v_add_f32 v55, v55, v71
    v_mfma_f32_16x16x32_bf16 v[88:91], v[184:187], v[128:131], v[88:91]
    ds_read_b64_tr_b16 v[180:181], v7 offset:56064
    v_fmac_f32 v56, v68, v68
    v_mfma_f32_16x16x32_bf16 v[88:91], v[188:191], v[132:135], v[88:91]
    ds_read_b64_tr_b16 v[182:183], v7 offset:56576
    v_fmac_f32 v57, v69, v69
    v_mfma_f32_16x16x32_bf16 v[92:95], v[184:187], v[132:135], v[92:95]
    ds_read_b128 v[160:163], v4 offset:192
    v_fmac_f32 v58, v70, v70
    v_mfma_f32_16x16x32_bf16 v[92:95], v[188:191], v[136:139], v[92:95]
    ds_read_b128 v[164:167], v4 offset:256
    v_fmac_f32 v59, v71, v71
    v_mfma_f32_16x16x32_bf16 v[96:99], v[184:187], v[136:139], v[96:99]
    v_sub_f32 v64, v28, v60
    v_sub_f32 v65, v29, v61
    v_mfma_f32_16x16x32_bf16 v[96:99], v[188:191], v[140:143], v[96:99]
    v_sub_f32 v66, v30, v62
    v_sub_f32 v67, v31, v63
    v_mfma_f32_16x16x32_bf16 v[100:103], v[184:187], v[140:143], v[100:103]
    v_add_f32 v52, v52, v64
    v_add_f32 v53, v53, v65
    v_mfma_f32_16x16x32_bf16 v[100:103], v[188:191], v[144:147], v[100:103]
    v_add_f32 v54, v54, v66
    v_add_f32 v55, v55, v67
    v_mfma_f32_16x16x32_bf16 v[104:107], v[184:187], v[144:147], v[104:107]
    v_fmac_f32 v56, v64, v64
    v_fmac_f32 v57, v65, v65
    v_mfma_f32_16x16x32_bf16 v[104:107], v[188:191], v[148:151], v[104:107]
    v_fmac_f32 v58, v66, v66
    v_fmac_f32 v59, v67, v67
    v_mfma_f32_16x16x32_bf16 v[108:111], v[184:187], v[148:151], v[108:111]
    v_sub_f32 v68, v32, v60
    v_sub_f32 v69, v33, v61
    s_waitcnt lgkmcnt(7)
    v_mfma_f32_16x16x32_bf16 v[108:111], v[188:191], v[152:155], v[108:111]
    v_sub_f32 v70, v34, v62
    v_sub_f32 v71, v35, v63
    v_mfma_f32_16x16x32_bf16 v[112:115], v[184:187], v[152:155], v[112:115]
    v_add_f32 v52, v52, v68
    v_add_f32 v53, v53, v69
    s_waitcnt lgkmcnt(6)
    v_mfma_f32_16x16x32_bf16 v[112:115], v[188:191], v[156:159], v[112:115]
    v_add_f32 v54, v54, v70
    v_add_f32 v55, v55, v71
    s_waitcnt lgkmcnt(4)
    v_mfma_f32_16x16x32_bf16 v[84:87], v[176:179], v[132:135], v[84:87]
    ds_read_b64_tr_b16 v[184:185], v7 offset:60160
    v_fmac_f32 v56, v68, v68
    s_waitcnt lgkmcnt(3)
    v_mfma_f32_16x16x32_bf16 v[84:87], v[180:183], v[136:139], v[84:87]
    ds_read_b64_tr_b16 v[186:187], v7 offset:60672
    v_fmac_f32 v57, v69, v69
    v_mfma_f32_16x16x32_bf16 v[88:91], v[176:179], v[136:139], v[88:91]
    ds_read_b64_tr_b16 v[188:189], v7 offset:64256
    v_fmac_f32 v58, v70, v70
    v_mfma_f32_16x16x32_bf16 v[88:91], v[180:183], v[140:143], v[88:91]
    ds_read_b64_tr_b16 v[190:191], v7 offset:64768
    v_fmac_f32 v59, v71, v71
    v_mfma_f32_16x16x32_bf16 v[92:95], v[176:179], v[140:143], v[92:95]
    ds_read_b128 v[168:171], v4 offset:320
    v_sub_f32 v64, v36, v60
    v_mfma_f32_16x16x32_bf16 v[92:95], v[180:183], v[144:147], v[92:95]
    ds_read_b128 v[172:175], v4 offset:384
    v_sub_f32 v65, v37, v61
    v_mfma_f32_16x16x32_bf16 v[96:99], v[176:179], v[144:147], v[96:99]
    v_sub_f32 v66, v38, v62
    v_sub_f32 v67, v39, v63
    v_mfma_f32_16x16x32_bf16 v[96:99], v[180:183], v[148:151], v[96:99]
    v_add_f32 v52, v52, v64
    v_add_f32 v53, v53, v65
    v_mfma_f32_16x16x32_bf16 v[100:103], v[176:179], v[148:151], v[100:103]
    v_add_f32 v54, v54, v66
    v_add_f32 v55, v55, v67
    v_mfma_f32_16x16x32_bf16 v[100:103], v[180:183], v[152:155], v[100:103]
    v_fmac_f32 v56, v64, v64
    v_fmac_f32 v57, v65, v65
    v_mfma_f32_16x16x32_bf16 v[104:107], v[176:179], v[152:155], v[104:107]
    v_fmac_f32 v58, v66, v66
    v_fmac_f32 v59, v67, v67
    v_mfma_f32_16x16x32_bf16 v[104:107], v[180:183], v[156:159], v[104:107]
    v_sub_f32 v68, v40, v60
    v_sub_f32 v69, v41, v61
    v_mfma_f32_16x16x32_bf16 v[108:111], v[176:179], v[156:159], v[108:111]
    v_sub_f32 v70, v42, v62
    v_sub_f32 v71, v43, v63
    s_waitcnt lgkmcnt(7)
    v_mfma_f32_16x16x32_bf16 v[108:111], v[180:183], v[160:163], v[108:111]
    v_add_f32 v52, v52, v68
    v_add_f32 v53, v53, v69
    v_mfma_f32_16x16x32_bf16 v[112:115], v[176:179], v[160:163], v[112:115]
    v_add_f32 v54, v54, v70
    v_add_f32 v55, v55, v71
    s_waitcnt lgkmcnt(6)
    v_mfma_f32_16x16x32_bf16 v[112:115], v[180:183], v[164:167], v[112:115]
    v_fmac_f32 v56, v68, v68
    v_fmac_f32 v57, v69, v69
    s_add_u32 s60, s60, 9152
    s_cmp_ge_u32 s60, 27456
    s_cselect_b32 s60, 0, s60
    v_add_u32 v5, s60, v1
    v_add_u32 v6, s60, v2
    s_waitcnt lgkmcnt(0)
    s_barrier
    v_mfma_f32_16x16x32_bf16 v[84:87], v[184:187], v[140:143], v[84:87]
    ds_read_b64_tr_b16 v[176:177], v8 offset:2816
    v_fmac_f32 v58, v70, v70
    v_mfma_f32_16x16x32_bf16 v[84:87], v[188:191], v[144:147], v[84:87]
    ds_read_b64_tr_b16 v[178:179], v8 offset:3328
    v_fmac_f32 v59, v71, v71
    v_mfma_f32_16x16x32_bf16 v[88:91], v[184:187], v[144:147], v[88:91]
    ds_read_b128 v[116:119], v5 offset:0
    v_sub_f32 v64, v44, v60
    v_mfma_f32_16x16x32_bf16 v[88:91], v[188:191], v[148:151], v[88:91]
    ds_read_b128 v[120:123], v5 offset:64
    v_sub_f32 v65, v45, v61
    v_mfma_f32_16x16x32_bf16 v[92:95], v[184:187], v[148:151], v[92:95]
    ds_read_b64_tr_b16 v[180:181], v8 offset:6912
    v_sub_f32 v66, v46, v62
    v_mfma_f32_16x16x32_bf16 v[92:95], v[188:191], v[152:155], v[92:95]
    ds_read_b64_tr_b16 v[182:183], v8 offset:7424
    v_sub_f32 v67, v47, v63
    v_mfma_f32_16x16x32_bf16 v[96:99], v[184:187], v[152:155], v[96:99]
    ds_read_b128 v[124:127], v5 offset:128
    v_add_f32 v52, v52, v64
    v_mfma_f32_16x16x32_bf16 v[96:99], v[188:191], v[156:159], v[96:99]
    ds_read_b128 v[128:131], v5 offset:192
    v_add_f32 v53, v53, v65
    v_mfma_f32_16x16x32_bf16 v[100:103], v[184:187], v[156:159], v[100:103]
    ds_read_b128 v[132:135], v5 offset:256
    v_add_f32 v54, v54, v66
    v_mfma_f32_16x16x32_bf16 v[100:103], v[188:191], v[160:163], v[100:103]
    ds_read_b128 v[136:139], v5 offset:320
    v_add_f32 v55, v55, v67
    v_mfma_f32_16x16x32_bf16 v[104:107], v[184:187], v[160:163], v[104:107]
    ds_read_b128 v[140:143], v5 offset:384
    v_fmac_f32 v56, v64, v64
    v_mfma_f32_16x16x32_bf16 v[104:107], v[188:191], v[164:167], v[104:107]
    ds_read_b128 v[144:147], v5 offset:448
    v_fmac_f32 v57, v65, v65
    v_mfma_f32_16x16x32_bf16 v[108:111], v[184:187], v[164:167], v[108:111]
    ds_read_b128 v[148:151], v6 offset:0
    v_fmac_f32 v58, v66, v66
    v_mfma_f32_16x16x32_bf16 v[108:111], v[188:191], v[168:171], v[108:111]
    v_fmac_f32 v59, v67, v67
    v_sub_f32 v68, v48, v60
    v_mfma_f32_16x16x32_bf16 v[112:115], v[184:187], v[168:171], v[112:115]
    v_sub_f32 v69, v49, v61
    v_sub_f32 v70, v50, v62
    v_mfma_f32_16x16x32_bf16 v[112:115], v[188:191], v[172:175], v[112:115]
    v_sub_f32 v71, v51, v63
    v_add_f32 v52, v52, v68
    v_add_f32 v53, v53, v69
    v_add_f32 v54, v54, v70
    v_add_f32 v55, v55, v71
    v_fmac_f32 v56, v68, v68
    v_fmac_f32 v57, v69, v69
    v_fmac_f32 v58, v70, v70
    v_fmac_f32 v59, v71, v71
    s_branch L_p2_s1
L_p2:
    s_waitcnt lgkmcnt(10)
    v_mfma_f32_16x16x32_bf16 v[84:87], v[176:179], v[116:119], v[84:87]
    ds_read_b64_tr_b16 v[184:185], v7 offset:43776
    s_waitcnt lgkmcnt(8)
    v_mfma_f32_16x16x32_bf16 v[84:87], v[180:183], v[120:123], v[84:87]
    ds_read_b64_tr_b16 v[186:187], v7 offset:44288
    v_mfma_f32_16x16x32_bf16 v[88:91], v[176:179], v[120:123], v[88:91]
    ds_read_b64_tr_b16 v[188:189], v7 offset:47872
    s_waitcnt lgkmcnt(9)
    v_mfma_f32_16x16x32_bf16 v[88:91], v[180:183], v[124:127], v[88:91]
    ds_read_b64_tr_b16 v[190:191], v7 offset:48384
    v_mfma_f32_16x16x32_bf16 v[92:95], v[176:179], v[124:127], v[92:95]
    ds_read_b128 v[152:155], v4 offset:64
    s_waitcnt lgkmcnt(10)
    v_mfma_f32_16x16x32_bf16 v[92:95], v[180:183], v[128:131], v[92:95]
    ds_read_b128 v[156:159], v4 offset:128
    v_mfma_f32_16x16x32_bf16 v[96:99], v[176:179], v[128:131], v[96:99]
    s_waitcnt lgkmcnt(10)
    v_mfma_f32_16x16x32_bf16 v[96:99], v[180:183], v[132:135], v[96:99]
    v_mfma_f32_16x16x32_bf16 v[100:103], v[176:179], v[132:135], v[100:103]
    s_waitcnt lgkmcnt(9)
    v_mfma_f32_16x16x32_bf16 v[100:103], v[180:183], v[136:139], v[100:103]
    v_mfma_f32_16x16x32_bf16 v[104:107], v[176:179], v[136:139], v[104:107]
    s_waitcnt lgkmcnt(8)
    v_mfma_f32_16x16x32_bf16 v[104:107], v[180:183], v[140:143], v[104:107]
    v_mfma_f32_16x16x32_bf16 v[108:111], v[176:179], v[140:143], v[108:111]
    s_waitcnt lgkmcnt(7)
    v_mfma_f32_16x16x32_bf16 v[108:111], v[180:183], v[144:147], v[108:111]
    v_mfma_f32_16x16x32_bf16 v[112:115], v[176:179], v[144:147], v[112:115]
    s_waitcnt lgkmcnt(6)
    v_mfma_f32_16x16x32_bf16 v[112:115], v[180:183], v[148:151], v[112:115]
    s_waitcnt lgkmcnt(4)
    v_mfma_f32_16x16x32_bf16 v[84:87], v[184:187], v[124:127], v[84:87]
    ds_read_b64_tr_b16 v[176:177], v7 offset:51968
    s_waitcnt lgkmcnt(3)
    v_mfma_f32_16x16x32_bf16 v[84:87], v[188:191], v[128:131], v[84:87]
    ds_read_b64_tr_b16 v[178:179], v7 offset:52480
    v_mfma_f32_16x16x32_bf16 v[88:91], v[184:187], v[128:131], v[88:91]
    ds_read_b64_tr_b16 v[180:181], v7 offset:56064
    v_mfma_f32_16x16x32_bf16 v[88:91], v[188:191], v[132:135], v[88:91]
    ds_read_b64_tr_b16 v[182:183], v7 offset:56576
    v_mfma_f32_16x16x32_bf16 v[92:95], v[184:187], v[132:135], v[92:95]
    ds_read_b128 v[160:163], v4 offset:192
    v_mfma_f32_16x16x32_bf16 v[92:95], v[188:191], v[136:139], v[92:95]
    ds_read_b128 v[164:167], v4 offset:256
    v_mfma_f32_16x16x32_bf16 v[96:99], v[184:187], v[136:139], v[96:99]
    v_mfma_f32_16x16x32_bf16 v[96:99], v[188:191], v[140:143], v[96:99]
    v_mfma_f32_16x16x32_bf16 v[100:103], v[184:187], v[140:143], v[100:103]
    v_mfma_f32_16x16x32_bf16 v[100:103], v[188:191], v[144:147], v[100:103]
    v_mfma_f32_16x16x32_bf16 v[104:107], v[184:187], v[144:147], v[104:107]
    v_mfma_f32_16x16x32_bf16 v[104:107], v[188:191], v[148:151], v[104:107]
    v_mfma_f32_16x16x32_bf16 v[108:111], v[184:187], v[148:151], v[108:111]
    s_waitcnt lgkmcnt(7)
    v_mfma_f32_16x16x32_bf16 v[108:111], v[188:191], v[152:155], v[108:111]
    v_mfma_f32_16x16x32_bf16 v[112:115], v[184:187], v[152:155], v[112:115]
    s_waitcnt lgkmcnt(6)
    v_mfma_f32_16x16x32_bf16 v[112:115], v[188:191], v[156:159], v[112:115]
    s_waitcnt lgkmcnt(4)
    v_mfma_f32_16x16x32_bf16 v[84:87], v[176:179], v[132:135], v[84:87]
    ds_read_b64_tr_b16 v[184:185], v7 offset:60160
    s_waitcnt lgkmcnt(3)
    v_mfma_f32_16x16x32_bf16 v[84:87], v[180:183], v[136:139], v[84:87]
    ds_read_b64_tr_b16 v[186:187], v7 offset:60672
    v_mfma_f32_16x16x32_bf16 v[88:91], v[176:179], v[136:139], v[88:91]
    ds_read_b64_tr_b16 v[188:189], v7 offset:64256
    v_mfma_f32_16x16x32_bf16 v[88:91], v[180:183], v[140:143], v[88:91]
    ds_read_b64_tr_b16 v[190:191], v7 offset:64768
    v_mfma_f32_16x16x32_bf16 v[92:95], v[176:179], v[140:143], v[92:95]
    ds_read_b128 v[168:171], v4 offset:320
    v_mfma_f32_16x16x32_bf16 v[92:95], v[180:183], v[144:147], v[92:95]
    ds_read_b128 v[172:175], v4 offset:384
    v_mfma_f32_16x16x32_bf16 v[96:99], v[176:179], v[144:147], v[96:99]
    v_mfma_f32_16x16x32_bf16 v[96:99], v[180:183], v[148:151], v[96:99]
    v_mfma_f32_16x16x32_bf16 v[100:103], v[176:179], v[148:151], v[100:103]
    v_mfma_f32_16x16x32_bf16 v[100:103], v[180:183], v[152:155], v[100:103]
    v_mfma_f32_16x16x32_bf16 v[104:107], v[176:179], v[152:155], v[104:107]
    v_mfma_f32_16x16x32_bf16 v[104:107], v[180:183], v[156:159], v[104:107]
    v_mfma_f32_16x16x32_bf16 v[108:111], v[176:179], v[156:159], v[108:111]
    s_waitcnt lgkmcnt(7)
    v_mfma_f32_16x16x32_bf16 v[108:111], v[180:183], v[160:163], v[108:111]
    v_mfma_f32_16x16x32_bf16 v[112:115], v[176:179], v[160:163], v[112:115]
    s_waitcnt lgkmcnt(6)
    v_mfma_f32_16x16x32_bf16 v[112:115], v[180:183], v[164:167], v[112:115]
    s_add_u32 s60, s60, 9152
    s_cmp_ge_u32 s60, 27456
    s_cselect_b32 s60, 0, s60
    v_add_u32 v5, s60, v1
    v_add_u32 v6, s60, v2
    s_waitcnt lgkmcnt(0)
    s_barrier
    v_mfma_f32_16x16x32_bf16 v[84:87], v[184:187], v[140:143], v[84:87]
    ds_read_b64_tr_b16 v[176:177], v8 offset:2816
    v_mfma_f32_16x16x32_bf16 v[84:87], v[188:191], v[144:147], v[84:87]
    ds_read_b64_tr_b16 v[178:179], v8 offset:3328
    v_mfma_f32_16x16x32_bf16 v[88:91], v[184:187], v[144:147], v[88:91]
    ds_read_b128 v[116:119], v5 offset:0
    v_mfma_f32_16x16x32_bf16 v[88:91], v[188:191], v[148:151], v[88:91]
    ds_read_b128 v[120:123], v5 offset:64
    v_mfma_f32_16x16x32_bf16 v[92:95], v[184:187], v[148:151], v[92:95]
    ds_read_b64_tr_b16 v[180:181], v8 offset:6912
    v_mfma_f32_16x16x32_bf16 v[92:95], v[188:191], v[152:155], v[92:95]
    ds_read_b64_tr_b16 v[182:183], v8 offset:7424
    v_mfma_f32_16x16x32_bf16 v[96:99], v[184:187], v[152:155], v[96:99]
    ds_read_b128 v[124:127], v5 offset:128
    v_mfma_f32_16x16x32_bf16 v[96:99], v[188:191], v[156:159], v[96:99]
    ds_read_b128 v[128:131], v5 offset:192
    v_mfma_f32_16x16x32_bf16 v[100:103], v[184:187], v[156:159], v[100:103]
    ds_read_b128 v[132:135], v5 offset:256
    v_mfma_f32_16x16x32_bf16 v[100:103], v[188:191], v[160:163], v[100:103]
    ds_read_b128 v[136:139], v5 offset:320
    v_mfma_f32_16x16x32_bf16 v[104:107], v[184:187], v[160:163], v[104:107]
    ds_read_b128 v[140:143], v5 offset:384
    v_mfma_f32_16x16x32_bf16 v[104:107], v[188:191], v[164:167], v[104:107]
    ds_read_b128 v[144:147], v5 offset:448
    v_mfma_f32_16x16x32_bf16 v[108:111], v[184:187], v[164:167], v[108:111]
    ds_read_b128 v[148:151], v6 offset:0
    v_mfma_f32_16x16x32_bf16 v[108:111], v[188:191], v[168:171], v[108:111]
    v_mfma_f32_16x16x32_bf16 v[112:115], v[184:187], v[168:171], v[112:115]
    v_mfma_f32_16x16x32_bf16 v[112:115], v[188:191], v[172:175], v[112:115]
L_p2_s1:
    s_waitcnt lgkmcnt(10)
    v_mfma_f32_16x16x32_bf16 v[84:87], v[176:179], v[116:119], v[84:87]
    ds_read_b64_tr_b16 v[184:185], v8 offset:11008
    s_waitcnt lgkmcnt(8)
    v_mfma_f32_16x16x32_bf16 v[84:87], v[180:183], v[120:123], v[84:87]
    ds_read_b64_tr_b16 v[186:187], v8 offset:11520
    v_mfma_f32_16x16x32_bf16 v[88:91], v[176:179], v[120:123], v[88:91]
    ds_read_b64_tr_b16 v[188:189], v8 offset:15104
    s_waitcnt lgkmcnt(9)
    v_mfma_f32_16x16x32_bf16 v[88:91], v[180:183], v[124:127], v[88:91]
    ds_read_b64_tr_b16 v[190:191], v8 offset:15616
    v_mfma_f32_16x16x32_bf16 v[92:95], v[176:179], v[124:127], v[92:95]
    ds_read_b128 v[152:155], v6 offset:64
    s_waitcnt lgkmcnt(10)
    v_mfma_f32_16x16x32_bf16 v[92:95], v[180:183], v[128:131], v[92:95]
    ds_read_b128 v[156:159], v6 offset:128
    v_mfma_f32_16x16x32_bf16 v[96:99], v[176:179], v[128:131], v[96:99]
    s_waitcnt lgkmcnt(10)
    v_mfma_f32_16x16x32_bf16 v[96:99], v[180:183], v[132:135], v[96:99]
    v_mfma_f32_16x16x32_bf16 v[100:103], v[176:179], v[132:135], v[100:103]
    s_waitcnt lgkmcnt(9)
    v_mfma_f32_16x16x32_bf16 v[100:103], v[180:183], v[136:139], v[100:103]
    v_mfma_f32_16x16x32_bf16 v[104:107], v[176:179], v[136:139], v[104:107]
    s_waitcnt lgkmcnt(8)
    v_mfma_f32_16x16x32_bf16 v[104:107], v[180:183], v[140:143], v[104:107]
    v_mfma_f32_16x16x32_bf16 v[108:111], v[176:179], v[140:143], v[108:111]
    s_waitcnt lgkmcnt(7)
    v_mfma_f32_16x16x32_bf16 v[108:111], v[180:183], v[144:147], v[108:111]
    v_mfma_f32_16x16x32_bf16 v[112:115], v[176:179], v[144:147], v[112:115]
    s_waitcnt lgkmcnt(6)
    v_mfma_f32_16x16x32_bf16 v[112:115], v[180:183], v[148:151], v[112:115]
    s_waitcnt lgkmcnt(4)
    v_mfma_f32_16x16x32_bf16 v[84:87], v[184:187], v[124:127], v[84:87]
    ds_read_b64_tr_b16 v[176:177], v8 offset:19200
    s_waitcnt lgkmcnt(3)
    v_mfma_f32_16x16x32_bf16 v[84:87], v[188:191], v[128:131], v[84:87]
    ds_read_b64_tr_b16 v[178:179], v8 offset:19712
    v_mfma_f32_16x16x32_bf16 v[88:91], v[184:187], v[128:131], v[88:91]
    ds_read_b64_tr_b16 v[180:181], v8 offset:23296
    v_mfma_f32_16x16x32_bf16 v[88:91], v[188:191], v[132:135], v[88:91]
    ds_read_b64_tr_b16 v[182:183], v8 offset:23808
    v_mfma_f32_16x16x32_bf16 v[92:95], v[184:187], v[132:135], v[92:95]
    ds_read_b128 v[160:163], v6 offset:192
    v_mfma_f32_16x16x32_bf16 v[92:95], v[188:191], v[136:139], v[92:95]
    ds_read_b128 v[164:167], v6 offset:256
    v_mfma_f32_16x16x32_bf16 v[96:99], v[184:187], v[136:139], v[96:99]
    v_mfma_f32_16x16x32_bf16 v[96:99], v[188:191], v[140:143], v[96:99]
    v_mfma_f32_16x16x32_bf16 v[100:103], v[184:187], v[140:143], v[100:103]
    v_mfma_f32_16x16x32_bf16 v[100:103], v[188:191], v[144:147], v[100:103]
    v_mfma_f32_16x16x32_bf16 v[104:107], v[184:187], v[144:147], v[104:107]
    v_mfma_f32_16x16x32_bf16 v[104:107], v[188:191], v[148:151], v[104:107]
    v_mfma_f32_16x16x32_bf16 v[108:111], v[184:187], v[148:151], v[108:111]
    s_waitcnt lgkmcnt(7)
    v_mfma_f32_16x16x32_bf16 v[108:111], v[188:191], v[152:155], v[108:111]
    v_mfma_f32_16x16x32_bf16 v[112:115], v[184:187], v[152:155], v[112:115]
    s_waitcnt lgkmcnt(6)
    v_mfma_f32_16x16x32_bf16 v[112:115], v[188:191], v[156:159], v[112:115]
    s_waitcnt lgkmcnt(4)
    v_mfma_f32_16x16x32_bf16 v[84:87], v[176:179], v[132:135], v[84:87]
    ds_read_b64_tr_b16 v[184:185], v8 offset:27392
    s_waitcnt lgkmcnt(3)
    v_mfma_f32_16x16x32_bf16 v[84:87], v[180:183], v[136:139], v[84:87]
    ds_read_b64_tr_b16 v[186:187], v8 offset:27904
    v_mfma_f32_16x16x32_bf16 v[88:91], v[176:179], v[136:139], v[88:91]
    ds_read_b64_tr_b16 v[188:189], v8 offset:31488
    v_mfma_f32_16x16x32_bf16 v[88:91], v[180:183], v[140:143], v[88:91]
    ds_read_b64_tr_b16 v[190:191], v8 offset:32000
    v_mfma_f32_16x16x32_bf16 v[92:95], v[176:179], v[140:143], v[92:95]
    ds_read_b128 v[168:171], v6 offset:320
    v_mfma_f32_16x16x32_bf16 v[92:95], v[180:183], v[144:147], v[92:95]
    ds_read_b128 v[172:175], v6 offset:384
    v_mfma_f32_16x16x32_bf16 v[96:99], v[176:179], v[144:147], v[96:99]
    v_mfma_f32_16x16x32_bf16 v[96:99], v[180:183], v[148:151], v[96:99]
    v_mfma_f32_16x16x32_bf16 v[100:103], v[176:179], v[148:151], v[100:103]
    v_mfma_f32_16x16x32_bf16 v[100:103], v[180:183], v[152:155], v[100:103]
    v_mfma_f32_16x16x32_bf16 v[104:107], v[176:179], v[152:155], v[104:107]
    v_mfma_f32_16x16x32_bf16 v[104:107], v[180:183], v[156:159], v[104:107]
    v_mfma_f32_16x16x32_bf16 v[108:111], v[176:179], v[156:159], v[108:111]
    s_waitcnt lgkmcnt(7)
    v_mfma_f32_16x16x32_bf16 v[108:111], v[180:183], v[160:163], v[108:111]
    v_mfma_f32_16x16x32_bf16 v[112:115], v[176:179], v[160:163], v[112:115]
    s_waitcnt lgkmcnt(6)
    v_mfma_f32_16x16x32_bf16 v[112:115], v[180:183], v[164:167], v[112:115]
    s_add_u32 s60, s60, 9152
    s_cmp_ge_u32 s60, 27456
    s_cselect_b32 s60, 0, s60
    v_add_u32 v3, s60, v1
    v_add_u32 v4, s60, v2
    s_waitcnt lgkmcnt(0)
    s_barrier
    v_mfma_f32_16x16x32_bf16 v[84:87], v[184:187], v[140:143], v[84:87]
    ds_read_b64_tr_b16 v[176:177], v8 offset:35584
    v_mfma_f32_16x16x32_bf16 v[84:87], v[188:191], v[144:147], v[84:87]
    ds_read_b64_tr_b16 v[178:179], v8 offset:36096
    v_mfma_f32_16x16x32_bf16 v[88:91], v[184:187], v[144:147], v[88:91]
    ds_read_b128 v[116:119], v3 offset:0
    v_mfma_f32_16x16x32_bf16 v[88:91], v[188:191], v[148:151], v[88:91]
    ds_read_b128 v[120:123], v3 offset:64
    v_mfma_f32_16x16x32_bf16 v[92:95], v[184:187], v[148:151], v[92:95]
    ds_read_b64_tr_b16 v[180:181], v8 offset:39680
    v_mfma_f32_16x16x32_bf16 v[92:95], v[188:191], v[152:155], v[92:95]
    ds_read_b64_tr_b16 v[182:183], v8 offset:40192
    v_mfma_f32_16x16x32_bf16 v[96:99], v[184:187], v[152:155], v[96:99]
    ds_read_b128 v[124:127], v3 offset:128
    v_mfma_f32_16x16x32_bf16 v[96:99], v[188:191], v[156:159], v[96:99]
    ds_read_b128 v[128:131], v3 offset:192
    v_mfma_f32_16x16x32_bf16 v[100:103], v[184:187], v[156:159], v[100:103]
    ds_read_b128 v[132:135], v3 offset:256
    v_mfma_f32_16x16x32_bf16 v[100:103], v[188:191], v[160:163], v[100:103]
    ds_read_b128 v[136:139], v3 offset:320
    v_mfma_f32_16x16x32_bf16 v[104:107], v[184:187], v[160:163], v[104:107]
    ds_read_b128 v[140:143], v3 offset:384
    v_mfma_f32_16x16x32_bf16 v[104:107], v[188:191], v[164:167], v[104:107]
    ds_read_b128 v[144:147], v3 offset:448
    v_mfma_f32_16x16x32_bf16 v[108:111], v[184:187], v[164:167], v[108:111]
    ds_read_b128 v[148:151], v4 offset:0
    v_mfma_f32_16x16x32_bf16 v[108:111], v[188:191], v[168:171], v[108:111]
    v_mfma_f32_16x16x32_bf16 v[112:115], v[184:187], v[168:171], v[112:115]
    v_mfma_f32_16x16x32_bf16 v[112:115], v[188:191], v[172:175], v[112:115]
    s_waitcnt lgkmcnt(10)
    v_mfma_f32_16x16x32_bf16 v[84:87], v[176:179], v[116:119], v[84:87]
    ds_read_b64_tr_b16 v[184:185], v8 offset:43776
    s_waitcnt lgkmcnt(8)
    v_mfma_f32_16x16x32_bf16 v[84:87], v[180:183], v[120:123], v[84:87]
    ds_read_b64_tr_b16 v[186:187], v8 offset:44288
    v_mfma_f32_16x16x32_bf16 v[88:91], v[176:179], v[120:123], v[88:91]
    ds_read_b64_tr_b16 v[188:189], v8 offset:47872
    s_waitcnt lgkmcnt(9)
    v_mfma_f32_16x16x32_bf16 v[88:91], v[180:183], v[124:127], v[88:91]
    ds_read_b64_tr_b16 v[190:191], v8 offset:48384
    v_mfma_f32_16x16x32_bf16 v[92:95], v[176:179], v[124:127], v[92:95]
    ds_read_b128 v[152:155], v4 offset:64
    s_waitcnt lgkmcnt(10)
    v_mfma_f32_16x16x32_bf16 v[92:95], v[180:183], v[128:131], v[92:95]
    ds_read_b128 v[156:159], v4 offset:128
    v_mfma_f32_16x16x32_bf16 v[96:99], v[176:179], v[128:131], v[96:99]
    s_waitcnt lgkmcnt(10)
    v_mfma_f32_16x16x32_bf16 v[96:99], v[180:183], v[132:135], v[96:99]
    v_mfma_f32_16x16x32_bf16 v[100:103], v[176:179], v[132:135], v[100:103]
    s_waitcnt lgkmcnt(9)
    v_mfma_f32_16x16x32_bf16 v[100:103], v[180:183], v[136:139], v[100:103]
    v_mfma_f32_16x16x32_bf16 v[104:107], v[176:179], v[136:139], v[104:107]
    s_waitcnt lgkmcnt(8)
    v_mfma_f32_16x16x32_bf16 v[104:107], v[180:183], v[140:143], v[104:107]
    v_mfma_f32_16x16x32_bf16 v[108:111], v[176:179], v[140:143], v[108:111]
    s_waitcnt lgkmcnt(7)
    v_mfma_f32_16x16x32_bf16 v[108:111], v[180:183], v[144:147], v[108:111]
    v_mfma_f32_16x16x32_bf16 v[112:115], v[176:179], v[144:147], v[112:115]
    s_waitcnt lgkmcnt(6)
    v_mfma_f32_16x16x32_bf16 v[112:115], v[180:183], v[148:151], v[112:115]
    s_waitcnt lgkmcnt(4)
    v_mfma_f32_16x16x32_bf16 v[84:87], v[184:187], v[124:127], v[84:87]
    ds_read_b64_tr_b16 v[176:177], v8 offset:51968
    s_waitcnt lgkmcnt(3)
    v_mfma_f32_16x16x32_bf16 v[84:87], v[188:191], v[128:131], v[84:87]
    ds_read_b64_tr_b16 v[178:179], v8 offset:52480
    v_mfma_f32_16x16x32_bf16 v[88:91], v[184:187], v[128:131], v[88:91]
    ds_read_b64_tr_b16 v[180:181], v8 offset:56064
    v_mfma_f32_16x16x32_bf16 v[88:91], v[188:191], v[132:135], v[88:91]
    ds_read_b64_tr_b16 v[182:183], v8 offset:56576
    v_mfma_f32_16x16x32_bf16 v[92:95], v[184:187], v[132:135], v[92:95]
    ds_read_b128 v[160:163], v4 offset:192
    v_mfma_f32_16x16x32_bf16 v[92:95], v[188:191], v[136:139], v[92:95]
    ds_read_b128 v[164:167], v4 offset:256
    v_mfma_f32_16x16x32_bf16 v[96:99], v[184:187], v[136:139], v[96:99]
    v_mfma_f32_16x16x32_bf16 v[96:99], v[188:191], v[140:143], v[96:99]
    v_mfma_f32_16x16x32_bf16 v[100:103], v[184:187], v[140:143], v[100:103]
    v_mfma_f32_16x16x32_bf16 v[100:103], v[188:191], v[144:147], v[100:103]
    v_mfma_f32_16x16x32_bf16 v[104:107], v[184:187], v[144:147], v[104:107]
    v_mfma_f32_16x16x32_bf16 v[104:107], v[188:191], v[148:151], v[104:107]
    v_mfma_f32_16x16x32_bf16 v[108:111], v[184:187], v[148:151], v[108:111]
    s_waitcnt lgkmcnt(7)
    v_mfma_f32_16x16x32_bf16 v[108:111], v[188:191], v[152:155], v[108:111]
    v_mfma_f32_16x16x32_bf16 v[112:115], v[184:187], v[152:155], v[112:115]
    s_waitcnt lgkmcnt(6)
    v_mfma_f32_16x16x32_bf16 v[112:115], v[188:191], v[156:159], v[112:115]
    s_waitcnt lgkmcnt(4)
    v_mfma_f32_16x16x32_bf16 v[84:87], v[176:179], v[132:135], v[84:87]
    ds_read_b64_tr_b16 v[184:185], v8 offset:60160
    s_waitcnt lgkmcnt(3)
    v_mfma_f32_16x16x32_bf16 v[84:87], v[180:183], v[136:139], v[84:87]
    ds_read_b64_tr_b16 v[186:187], v8 offset:60672
    v_mfma_f32_16x16x32_bf16 v[88:91], v[176:179], v[136:139], v[88:91]
    ds_read_b64_tr_b16 v[188:189], v8 offset:64256
    v_mfma_f32_16x16x32_bf16 v[88:91], v[180:183], v[140:143], v[88:91]
    ds_read_b64_tr_b16 v[190:191], v8 offset:64768
    v_mfma_f32_16x16x32_bf16 v[92:95], v[176:179], v[140:143], v[92:95]
    ds_read_b128 v[168:171], v4 offset:320
    v_mfma_f32_16x16x32_bf16 v[92:95], v[180:183], v[144:147], v[92:95]
    ds_read_b128 v[172:175], v4 offset:384
    v_mfma_f32_16x16x32_bf16 v[96:99], v[176:179], v[144:147], v[96:99]
    v_mfma_f32_16x16x32_bf16 v[96:99], v[180:183], v[148:151], v[96:99]
    v_mfma_f32_16x16x32_bf16 v[100:103], v[176:179], v[148:151], v[100:103]
    v_mfma_f32_16x16x32_bf16 v[100:103], v[180:183], v[152:155], v[100:103]
    v_mfma_f32_16x16x32_bf16 v[104:107], v[176:179], v[152:155], v[104:107]
    v_mfma_f32_16x16x32_bf16 v[104:107], v[180:183], v[156:159], v[104:107]
    v_mfma_f32_16x16x32_bf16 v[108:111], v[176:179], v[156:159], v[108:111]
    s_waitcnt lgkmcnt(7)
    v_mfma_f32_16x16x32_bf16 v[108:111], v[180:183], v[160:163], v[108:111]
    v_mfma_f32_16x16x32_bf16 v[112:115], v[176:179], v[160:163], v[112:115]
    s_waitcnt lgkmcnt(6)
    v_mfma_f32_16x16x32_bf16 v[112:115], v[180:183], v[164:167], v[112:115]
    s_add_u32 s60, s60, 9152
    s_cmp_ge_u32 s60, 27456
    s_cselect_b32 s60, 0, s60
    v_add_u32 v5, s60, v1
    v_add_u32 v6, s60, v2
    s_waitcnt lgkmcnt(0)
    s_barrier
    v_mfma_f32_16x16x32_bf16 v[84:87], v[184:187], v[140:143], v[84:87]
    ds_read_b64_tr_b16 v[176:177], v9 offset:2816
    v_mfma_f32_16x16x32_bf16 v[84:87], v[188:191], v[144:147], v[84:87]
    ds_read_b64_tr_b16 v[178:179], v9 offset:3328
    v_mfma_f32_16x16x32_bf16 v[88:91], v[184:187], v[144:147], v[88:91]
    ds_read_b128 v[116:119], v5 offset:0
    v_mfma_f32_16x16x32_bf16 v[88:91], v[188:191], v[148:151], v[88:91]
    ds_read_b128 v[120:123], v5 offset:64
    v_mfma_f32_16x16x32_bf16 v[92:95], v[184:187], v[148:151], v[92:95]
    ds_read_b64_tr_b16 v[180:181], v9 offset:6912
    v_mfma_f32_16x16x32_bf16 v[92:95], v[188:191], v[152:155], v[92:95]
    ds_read_b64_tr_b16 v[182:183], v9 offset:7424
    v_mfma_f32_16x16x32_bf16 v[96:99], v[184:187], v[152:155], v[96:99]
    ds_read_b128 v[124:127], v5 offset:128
    v_mfma_f32_16x16x32_bf16 v[96:99], v[188:191], v[156:159], v[96:99]
    ds_read_b128 v[128:131], v5 offset:192
    v_mfma_f32_16x16x32_bf16 v[100:103], v[184:187], v[156:159], v[100:103]
    ds_read_b128 v[132:135], v5 offset:256
    v_mfma_f32_16x16x32_bf16 v[100:103], v[188:191], v[160:163], v[100:103]
    ds_read_b128 v[136:139], v5 offset:320
    v_mfma_f32_16x16x32_bf16 v[104:107], v[184:187], v[160:163], v[104:107]
    ds_read_b128 v[140:143], v5 offset:384
    v_mfma_f32_16x16x32_bf16 v[104:107], v[188:191], v[164:167], v[104:107]
    ds_read_b128 v[144:147], v5 offset:448
    v_mfma_f32_16x16x32_bf16 v[108:111], v[184:187], v[164:167], v[108:111]
    ds_read_b128 v[148:151], v6 offset:0
    v_mfma_f32_16x16x32_bf16 v[108:111], v[188:191], v[168:171], v[108:111]
    v_mfma_f32_16x16x32_bf16 v[112:115], v[184:187], v[168:171], v[112:115]
    v_mfma_f32_16x16x32_bf16 v[112:115], v[188:191], v[172:175], v[112:115]
    s_waitcnt lgkmcnt(10)
    v_mfma_f32_16x16x32_bf16 v[84:87], v[176:179], v[116:119], v[84:87]
    ds_read_b64_tr_b16 v[184:185], v9 offset:11008
    s_waitcnt lgkmcnt(8)
    v_mfma_f32_16x16x32_bf16 v[84:87], v[180:183], v[120:123], v[84:87]
    ds_read_b64_tr_b16 v[186:187], v9 offset:11520
    v_mfma_f32_16x16x32_bf16 v[88:91], v[176:179], v[120:123], v[88:91]
    ds_read_b64_tr_b16 v[188:189], v9 offset:15104
    s_waitcnt lgkmcnt(9)
    v_mfma_f32_16x16x32_bf16 v[88:91], v[180:183], v[124:127], v[88:91]
    ds_read_b64_tr_b16 v[190:191], v9 offset:15616
    v_mfma_f32_16x16x32_bf16 v[92:95], v[176:179], v[124:127], v[92:95]
    ds_read_b128 v[152:155], v6 offset:64
    s_waitcnt lgkmcnt(10)
    v_mfma_f32_16x16x32_bf16 v[92:95], v[180:183], v[128:131], v[92:95]
    ds_read_b128 v[156:159], v6 offset:128
    v_mfma_f32_16x16x32_bf16 v[96:99], v[176:179], v[128:131], v[96:99]
    s_waitcnt lgkmcnt(10)
    v_mfma_f32_16x16x32_bf16 v[96:99], v[180:183], v[132:135], v[96:99]
    v_mfma_f32_16x16x32_bf16 v[100:103], v[176:179], v[132:135], v[100:103]
    s_waitcnt lgkmcnt(9)
    v_mfma_f32_16x16x32_bf16 v[100:103], v[180:183], v[136:139], v[100:103]
    v_mfma_f32_16x16x32_bf16 v[104:107], v[176:179], v[136:139], v[104:107]
    s_waitcnt lgkmcnt(8)
    v_mfma_f32_16x16x32_bf16 v[104:107], v[180:183], v[140:143], v[104:107]
    v_mfma_f32_16x16x32_bf16 v[108:111], v[176:179], v[140:143], v[108:111]
    s_waitcnt lgkmcnt(7)
    v_mfma_f32_16x16x32_bf16 v[108:111], v[180:183], v[144:147], v[108:111]
    v_mfma_f32_16x16x32_bf16 v[112:115], v[176:179], v[144:147], v[112:115]
    s_waitcnt lgkmcnt(6)
    v_mfma_f32_16x16x32_bf16 v[112:115], v[180:183], v[148:151], v[112:115]
    s_waitcnt lgkmcnt(4)
    v_mfma_f32_16x16x32_bf16 v[84:87], v[184:187], v[124:127], v[84:87]
    ds_read_b64_tr_b16 v[176:177], v9 offset:19200
    s_waitcnt lgkmcnt(3)
    v_mfma_f32_16x16x32_bf16 v[84:87], v[188:191], v[128:131], v[84:87]
    ds_read_b64_tr_b16 v[178:179], v9 offset:19712
    v_mfma_f32_16x16x32_bf16 v[88:91], v[184:187], v[128:131], v[88:91]
    ds_read_b64_tr_b16 v[180:181], v9 offset:23296
    v_mfma_f32_16x16x32_bf16 v[88:91], v[188:191], v[132:135], v[88:91]
    ds_read_b64_tr_b16 v[182:183], v9 offset:23808
    v_mfma_f32_16x16x32_bf16 v[92:95], v[184:187], v[132:135], v[92:95]
    ds_read_b128 v[160:163], v6 offset:192
    v_mfma_f32_16x16x32_bf16 v[92:95], v[188:191], v[136:139], v[92:95]
    ds_read_b128 v[164:167], v6 offset:256
    v_mfma_f32_16x16x32_bf16 v[96:99], v[184:187], v[136:139], v[96:99]
    v_mfma_f32_16x16x32_bf16 v[96:99], v[188:191], v[140:143], v[96:99]
    v_mfma_f32_16x16x32_bf16 v[100:103], v[184:187], v[140:143], v[100:103]
    v_mfma_f32_16x16x32_bf16 v[100:103], v[188:191], v[144:147], v[100:103]
    v_mfma_f32_16x16x32_bf16 v[104:107], v[184:187], v[144:147], v[104:107]
    v_mfma_f32_16x16x32_bf16 v[104:107], v[188:191], v[148:151], v[104:107]
    v_mfma_f32_16x16x32_bf16 v[108:111], v[184:187], v[148:151], v[108:111]
    s_waitcnt lgkmcnt(7)
    v_mfma_f32_16x16x32_bf16 v[108:111], v[188:191], v[152:155], v[108:111]
    v_mfma_f32_16x16x32_bf16 v[112:115], v[184:187], v[152:155], v[112:115]
    s_waitcnt lgkmcnt(6)
    v_mfma_f32_16x16x32_bf16 v[112:115], v[188:191], v[156:159], v[112:115]
    s_waitcnt lgkmcnt(4)
    v_mfma_f32_16x16x32_bf16 v[84:87], v[176:179], v[132:135], v[84:87]
    ds_read_b64_tr_b16 v[184:185], v9 offset:27392
    s_waitcnt lgkmcnt(3)
    v_mfma_f32_16x16x32_bf16 v[84:87], v[180:183], v[136:139], v[84:87]
    ds_read_b64_tr_b16 v[186:187], v9 offset:27904
    v_mfma_f32_16x16x32_bf16 v[88:91], v[176:179], v[136:139], v[88:91]
    ds_read_b64_tr_b16 v[188:189], v7 offset:27456
    v_mfma_f32_16x16x32_bf16 v[88:91], v[180:183], v[140:143], v[88:91]
    ds_read_b64_tr_b16 v[190:191], v7 offset:27968
    v_mfma_f32_16x16x32_bf16 v[92:95], v[176:179], v[140:143], v[92:95]
    ds_read_b128 v[168:171], v6 offset:320
    v_mfma_f32_16x16x32_bf16 v[92:95], v[180:183], v[144:147], v[92:95]
    ds_read_b128 v[172:175], v6 offset:384
    v_mfma_f32_16x16x32_bf16 v[96:99], v[176:179], v[144:147], v[96:99]
    v_mfma_f32_16x16x32_bf16 v[96:99], v[180:183], v[148:151], v[96:99]
    v_mfma_f32_16x16x32_bf16 v[100:103], v[176:179], v[148:151], v[100:103]
    v_mfma_f32_16x16x32_bf16 v[100:103], v[180:183], v[152:155], v[100:103]
    v_mfma_f32_16x16x32_bf16 v[104:107], v[176:179], v[152:155], v[104:107]
    v_mfma_f32_16x16x32_bf16 v[104:107], v[180:183], v[156:159], v[104:107]
    v_mfma_f32_16x16x32_bf16 v[108:111], v[176:179], v[156:159], v[108:111]
    s_waitcnt lgkmcnt(7)
    v_mfma_f32_16x16x32_bf16 v[108:111], v[180:183], v[160:163], v[108:111]
    v_mfma_f32_16x16x32_bf16 v[112:115], v[176:179], v[160:163], v[112:115]
    s_waitcnt lgkmcnt(6)
    v_mfma_f32_16x16x32_bf16 v[112:115], v[180:183], v[164:167], v[112:115]
    s_add_u32 s60, s60, 9152
    s_cmp_ge_u32 s60, 27456
    s_cselect_b32 s60, 0, s60
    v_add_u32 v3, s60, v1
    v_add_u32 v4, s60, v2
    s_waitcnt lgkmcnt(0)
    s_barrier
    v_mfma_f32_16x16x32_bf16 v[84:87], v[184:187], v[140:143], v[84:87]
    ds_read_b64_tr_b16 v[176:177], v7 offset:35584
    v_mfma_f32_16x16x32_bf16 v[84:87], v[188:191], v[144:147], v[84:87]
    ds_read_b64_tr_b16 v[178:179], v7 offset:36096
    v_mfma_f32_16x16x32_bf16 v[88:91], v[184:187], v[144:147], v[88:91]
    ds_read_b128 v[116:119], v3 offset:0
    v_mfma_f32_16x16x32_bf16 v[88:91], v[188:191], v[148:151], v[88:91]
    ds_read_b128 v[120:123], v3 offset:64
    v_mfma_f32_16x16x32_bf16 v[92:95], v[184:187], v[148:151], v[92:95]
    ds_read_b64_tr_b16 v[180:181], v7 offset:39680
    v_mfma_f32_16x16x32_bf16 v[92:95], v[188:191], v[152:155], v[92:95]
    ds_read_b64_tr_b16 v[182:183], v7 offset:40192
    v_mfma_f32_16x16x32_bf16 v[96:99], v[184:187], v[152:155], v[96:99]
    ds_read_b128 v[124:127], v3 offset:128
    v_mfma_f32_16x16x32_bf16 v[96:99], v[188:191], v[156:159], v[96:99]
    ds_read_b128 v[128:131], v3 offset:192
    v_mfma_f32_16x16x32_bf16 v[100:103], v[184:187], v[156:159], v[100:103]
    ds_read_b128 v[132:135], v3 offset:256
    v_mfma_f32_16x16x32_bf16 v[100:103], v[188:191], v[160:163], v[100:103]
    ds_read_b128 v[136:139], v3 offset:320
    v_mfma_f32_16x16x32_bf16 v[104:107], v[184:187], v[160:163], v[104:107]
    ds_read_b128 v[140:143], v3 offset:384
    v_mfma_f32_16x16x32_bf16 v[104:107], v[188:191], v[164:167], v[104:107]
    ds_read_b128 v[144:147], v3 offset:448
    v_mfma_f32_16x16x32_bf16 v[108:111], v[184:187], v[164:167], v[108:111]
    ds_read_b128 v[148:151], v4 offset:0
    v_mfma_f32_16x16x32_bf16 v[108:111], v[188:191], v[168:171], v[108:111]
    v_mfma_f32_16x16x32_bf16 v[112:115], v[184:187], v[168:171], v[112:115]
    v_mfma_f32_16x16x32_bf16 v[112:115], v[188:191], v[172:175], v[112:115]
    s_cmp_lg_u32 s54, 0
    s_cbranch_scc1 L_nosig2
    s_cmp_lg_u32 s44, 0
    s_cbranch_scc1 L_nosig2
    v_mov_b32 v192, 48
    v_mov_b32 v193, 1
    s_mov_b64 exec, 1
    buffer_store_dword v193, v192, s[32:35], s73 offen sc1
    s_mov_b64 exec, -1
    s_nop 3
L_nosig2:
    s_add_u32 s54, s54, 1
    s_cmp_lt_u32 s54, 4
    s_cbranch_scc1 L_p2
    s_mov_b32 s61, 65536
    s_waitcnt lgkmcnt(0) vmcnt(0)
    s_cmp_eq_u32 s48, 31
    s_cselect_b32 s66, 5, 16
    s_cselect_b32 s67, 5, 15
    s_mov_b32 s71, 0x3b808081
    s_cselect_b32 s71, 0x3c4ccccd, s71
    v_cmp_gt_u32 s[62:63], s66, v10
    v_cmp_gt_u32 s[64:65], s67, v10
    v_pk_add_f32 v[64:65], v[84:85], v[60:61] neg_lo:[0,1] neg_hi:[0,1]
    v_pk_add_f32 v[66:67], v[86:87], v[62:63] neg_lo:[0,1] neg_hi:[0,1]
    v_pk_add_f32 v[52:53], v[52:53], v[64:65]
    v_pk_fma_f32 v[56:57], v[64:65], v[64:65], v[56:57]
    v_pk_add_f32 v[54:55], v[54:55], v[66:67]
    v_pk_fma_f32 v[58:59], v[66:67], v[66:67], v[58:59]
    v_pk_add_f32 v[68:69], v[88:89], v[60:61] neg_lo:[0,1] neg_hi:[0,1]
    v_pk_add_f32 v[70:71], v[90:91], v[62:63] neg_lo:[0,1] neg_hi:[0,1]
    v_pk_add_f32 v[52:53], v[52:53], v[68:69]
    v_pk_fma_f32 v[56:57], v[68:69], v[68:69], v[56:57]
    v_pk_add_f32 v[54:55], v[54:55], v[70:71]
    v_pk_fma_f32 v[58:59], v[70:71], v[70:71], v[58:59]
    v_pk_add_f32 v[64:65], v[92:93], v[60:61] neg_lo:[0,1] neg_hi:[0,1]
    v_pk_add_f32 v[66:67], v[94:95], v[62:63] neg_lo:[0,1] neg_hi:[0,1]
    v_pk_add_f32 v[52:53], v[52:53], v[64:65]
    v_pk_fma_f32 v[56:57], v[64:65], v[64:65], v[56:57]
    v_pk_add_f32 v[54:55], v[54:55], v[66:67]
    v_pk_fma_f32 v[58:59], v[66:67], v[66:67], v[58:59]
    v_pk_add_f32 v[68:69], v[96:97], v[60:61] neg_lo:[0,1] neg_hi:[0,1]
    v_pk_add_f32 v[70:71], v[98:99], v[62:63] neg_lo:[0,1] neg_hi:[0,1]
    v_pk_add_f32 v[52:53], v[52:53], v[68:69]
    v_pk_fma_f32 v[56:57], v[68:69], v[68:69], v[56:57]
    v_pk_add_f32 v[54:55], v[54:55], v[70:71]
    v_pk_fma_f32 v[58:59], v[70:71], v[70:71], v[58:59]
    v_pk_add_f32 v[64:65], v[100:101], v[60:61] neg_lo:[0,1] neg_hi:[0,1]
    v_pk_add_f32 v[66:67], v[102:103], v[62:63] neg_lo:[0,1] neg_hi:[0,1]
    v_pk_add_f32 v[52:53], v[52:53], v[64:65]
    v_pk_fma_f32 v[56:57], v[64:65], v[64:65], v[56:57]
    v_pk_add_f32 v[54:55], v[54:55], v[66:67]
    v_pk_fma_f32 v[58:59], v[66:67], v[66:67], v[58:59]
    v_pk_add_f32 v[68:69], v[104:105], v[60:61] neg_lo:[0,1] neg_hi:[0,1]
    v_pk_add_f32 v[70:71], v[106:107], v[62:63] neg_lo:[0,1] neg_hi:[0,1]
    v_pk_add_f32 v[52:53], v[52:53], v[68:69]
    v_pk_fma_f32 v[56:57], v[68:69], v[68:69], v[56:57]
    v_pk_add_f32 v[54:55], v[54:55], v[70:71]
    v_pk_fma_f32 v[58:59], v[70:71], v[70:71], v[58:59]
    v_pk_add_f32 v[64:65], v[108:109], v[60:61] neg_lo:[0,1] neg_hi:[0,1]
    v_pk_add_f32 v[66:67], v[110:111], v[62:63] neg_lo:[0,1] neg_hi:[0,1]
    v_pk_add_f32 v[52:53], v[52:53], v[64:65]
    v_pk_fma_f32 v[56:57], v[64:65], v[64:65], v[56:57]
    v_pk_add_f32 v[54:55], v[54:55], v[66:67]
    v_pk_fma_f32 v[58:59], v[66:67], v[66:67], v[58:59]
    s_mov_b64 exec, s[64:65]
    v_pk_add_f32 v[68:69], v[112:113], v[60:61] neg_lo:[0,1] neg_hi:[0,1]
    v_pk_add_f32 v[70:71], v[114:115], v[62:63] neg_lo:[0,1] neg_hi:[0,1]
    v_pk_add_f32 v[52:53], v[52:53], v[68:69]
    v_pk_fma_f32 v[56:57], v[68:69], v[68:69], v[56:57]
    v_pk_add_f32 v[54:55], v[54:55], v[70:71]
    v_pk_fma_f32 v[58:59], v[70:71], v[70:71], v[58:59]
    s_mov_b64 exec, -1
    v_cndmask_b32 v52, 0, v52, s[62:63]
    v_cndmask_b32 v53, 0, v53, s[62:63]
    v_cndmask_b32 v54, 0, v54, s[62:63]
    v_cndmask_b32 v55, 0, v55, s[62:63]
    v_cndmask_b32 v56, 0, v56, s[62:63]
    v_cndmask_b32 v57, 0, v57, s[62:63]
    v_cndmask_b32 v58, 0, v58, s[62:63]
    v_cndmask_b32 v59, 0, v59, s[62:63]
    v_add_f32_dpp v52, v52, v52 row_ror:8 row_mask:0xf bank_mask:0xf
    v_add_f32_dpp v53, v53, v53 row_ror:8 row_mask:0xf bank_mask:0xf
    v_add_f32_dpp v54, v54, v54 row_ror:8 row_mask:0xf bank_mask:0xf
    v_add_f32_dpp v55, v55, v55 row_ror:8 row_mask:0xf bank_mask:0xf
    v_add_f32_dpp v56, v56, v56 row_ror:8 row_mask:0xf bank_mask:0xf
    v_add_f32_dpp v57, v57, v57 row_ror:8 row_mask:0xf bank_mask:0xf
    v_add_f32_dpp v58, v58, v58 row_ror:8 row_mask:0xf bank_mask:0xf
    v_add_f32_dpp v59, v59, v59 row_ror:8 row_mask:0xf bank_mask:0xf
    v_add_f32_dpp v52, v52, v52 row_ror:4 row_mask:0xf bank_mask:0xf
    v_add_f32_dpp v53, v53, v53 row_ror:4 row_mask:0xf bank_mask:0xf
    v_add_f32_dpp v54, v54, v54 row_ror:4 row_mask:0xf bank_mask:0xf
    v_add_f32_dpp v55, v55, v55 row_ror:4 row_mask:0xf bank_mask:0xf
    v_add_f32_dpp v56, v56, v56 row_ror:4 row_mask:0xf bank_mask:0xf
    v_add_f32_dpp v57, v57, v57 row_ror:4 row_mask:0xf bank_mask:0xf
    v_add_f32_dpp v58, v58, v58 row_ror:4 row_mask:0xf bank_mask:0xf
    v_add_f32_dpp v59, v59, v59 row_ror:4 row_mask:0xf bank_mask:0xf
    v_add_f32_dpp v52, v52, v52 row_ror:2 row_mask:0xf bank_mask:0xf
    v_add_f32_dpp v53, v53, v53 row_ror:2 row_mask:0xf bank_mask:0xf
    v_add_f32_dpp v54, v54, v54 row_ror:2 row_mask:0xf bank_mask:0xf
    v_add_f32_dpp v55, v55, v55 row_ror:2 row_mask:0xf bank_mask:0xf
    v_add_f32_dpp v56, v56, v56 row_ror:2 row_mask:0xf bank_mask:0xf
    v_add_f32_dpp v57, v57, v57 row_ror:2 row_mask:0xf bank_mask:0xf
    v_add_f32_dpp v58, v58, v58 row_ror:2 row_mask:0xf bank_mask:0xf
    v_add_f32_dpp v59, v59, v59 row_ror:2 row_mask:0xf bank_mask:0xf
    v_add_f32_dpp v52, v52, v52 row_ror:1 row_mask:0xf bank_mask:0xf
    v_add_f32_dpp v53, v53, v53 row_ror:1 row_mask:0xf bank_mask:0xf
    v_add_f32_dpp v54, v54, v54 row_ror:1 row_mask:0xf bank_mask:0xf
    v_add_f32_dpp v55, v55, v55 row_ror:1 row_mask:0xf bank_mask:0xf
    v_add_f32_dpp v56, v56, v56 row_ror:1 row_mask:0xf bank_mask:0xf
    v_add_f32_dpp v57, v57, v57 row_ror:1 row_mask:0xf bank_mask:0xf
    v_add_f32_dpp v58, v58, v58 row_ror:1 row_mask:0xf bank_mask:0xf
    v_add_f32_dpp v59, v59, v59 row_ror:1 row_mask:0xf bank_mask:0xf
    v_mul_f32 v64, s71, v52
    v_mul_f32 v65, s71, v53
    v_mul_f32 v66, s71, v54
    v_mul_f32 v67, s71, v55
    v_fma_f32 v56, -v64, v52, v56
    v_add_f32 v52, v60, v64
    v_fma_f32 v57, -v65, v53, v57
    v_add_f32 v53, v61, v65
    v_fma_f32 v58, -v66, v54, v58
    v_add_f32 v54, v62, v66
    v_fma_f32 v59, -v67, v55, v59
    v_add_f32 v55, v63, v67
    v_max_f32 v56, 0, v56
    v_max_f32 v57, 0, v57
    v_max_f32 v58, 0, v58
    v_max_f32 v59, 0, v59
    v_or_b32 v52, 1, v52
    v_or_b32 v53, 1, v53
    v_or_b32 v54, 1, v54
    v_or_b32 v55, 1, v55
    v_or_b32 v56, 1, v56
    v_or_b32 v57, 1, v57
    v_or_b32 v58, 1, v58
    v_or_b32 v59, 1, v59
    v_cmp_eq_u32 vcc, 0, v10
    s_and_saveexec_b64 s[76:77], vcc
    buffer_store_dwordx4 v[52:55], v16, s[32:35], s58 offen sc1
    buffer_store_dwordx4 v[56:59], v16, s[32:35], s58 offen offset:64 sc1
    s_mov_b64 exec, -1
    v_lshlrev_b32 v1, 7, v10
    v_add_u32 v1, v1, v16
    buffer_load_dwordx4 v[136:139], v1, s[32:35], s72 offen sc1
    buffer_load_dwordx4 v[140:143], v1, s[32:35], s72 offen offset:64 sc1
    buffer_load_dwordx4 v[144:147], v1, s[32:35], s72 offen offset:2048 sc1
    buffer_load_dwordx4 v[148:151], v1, s[32:35], s72 offen offset:2112 sc1
    s_lshl_b32 s51, s44, 2
    v_add_u32 v5, s51, v11
    v_xor_b32 v5, v5, v10
    v_lshlrev_b32 v5, 4, v5
    v_lshlrev_b32 v3, 12, v10
    v_add3_u32 v5, v5, v3, s61
    ds_write_b128 v5, v[20:23] offset:0
    ds_write_b128 v5, v[84:87] offset:256
    ds_write_b128 v5, v[24:27] offset:512
    ds_write_b128 v5, v[88:91] offset:768
    ds_write_b128 v5, v[28:31] offset:1024
    ds_write_b128 v5, v[92:95] offset:1280
    ds_write_b128 v5, v[32:35] offset:1536
    ds_write_b128 v5, v[96:99] offset:1792
    ds_write_b128 v5, v[36:39] offset:2048
    ds_write_b128 v5, v[100:103] offset:2304
    ds_write_b128 v5, v[40:43] offset:2560
    ds_write_b128 v5, v[104:107] offset:2816
    ds_write_b128 v5, v[44:47] offset:3072
    ds_write_b128 v5, v[108:111] offset:3328
    ds_write_b128 v5, v[48:51] offset:3584
    ds_write_b128 v5, v[112:115] offset:3840
    s_mul_i32 s69, s47, 4088320
    s_mul_i32 s52, s48, 130560
    s_add_u32 s69, s69, s52
    s_add_u32 s69, s69, s50
    s_lshl_b32 s51, s75, 2
    s_add_u32 s51, s51, s44
    s_lshl_b32 s52, s51, 5
    v_lshrrev_b32 v7, 3, v0
    v_add_u32 v7, s52, v7
    v_and_b32 v3, 7, v0
    v_lshlrev_b32 v4, 9, v7
    v_lshlrev_b32 v8, 4, v3
    v_add_u32 v4, v4, v8
    v_lshlrev_b32 v2, 5, v3
    v_add_u32 v2, 40960, v2
    v_lshlrev_b32 v8, 8, v7
    v_add_u32 v8, 65536, v8
    v_lshlrev_b32 v3, 1, v3
    s_lshl_b32 s51, s51, 1
    v_or_b32 v176, 0, v3
    s_add_u32 s52, s51, 0
    v_xor_b32 v176, s52, v176
    v_lshlrev_b32 v176, 4, v176
    v_add_u32 v176, v176, v8
    v_or_b32 v177, 1, v3
    s_add_u32 s52, s51, 0
    v_xor_b32 v177, s52, v177
    v_lshlrev_b32 v177, 4, v177
    v_add_u32 v177, v177, v8
    v_or_b32 v178, 0, v3
    s_add_u32 s52, s51, 1
    v_xor_b32 v178, s52, v178
    v_lshlrev_b32 v178, 4, v178
    v_add_u32 v178, v178, v8
    v_or_b32 v179, 1, v3
    s_add_u32 s52, s51, 1
    v_xor_b32 v179, s52, v179
    v_lshlrev_b32 v179, 4, v179
    v_add_u32 v179, v179, v8
    v_mov_b32 v168, 0xc0135761
    v_mov_b32 v170, 0xbdd2d3e8
    v_mov_b32 v172, 1.0
    v_mov_b32 v169, 0xc0135761
    v_mov_b32 v171, 0xbdd2d3e8
    v_mov_b32 v173, 1.0
    v_mov_b32 v6, 41472
    s_cmp_eq_u32 s48, 31
    s_movk_i32 s68, 255
    s_cselect_b32 s68, 80, s68
    s_lshl_b32 s51, s44, 2
    v_add_u32 v9, s51, v6
    v_mov_b32 v3, 0
    ds_write_b32 v9, v3
    s_waitcnt lgkmcnt(0)
    s_barrier
    ds_read_b128 v[84:87], v176 offset:0
    ds_read_b128 v[88:91], v177 offset:0
    ds_read_b128 v[92:95], v176 offset:2048
    ds_read_b128 v[96:99], v177 offset:2048
    ds_read_b128 v[100:103], v178 offset:4096
    ds_read_b128 v[104:107], v179 offset:4096
    ds_read_b128 v[108:111], v178 offset:6144
    ds_read_b128 v[112:115], v179 offset:6144
    v_mov_b32 v17, 0x437f0000
    v_mov_b32 v3, 0x42a00000
    v_cmp_eq_u32 vcc, 15, v10
    v_lshlrev_b32 v152, 16, v12
    v_and_b32 v153, 0xffff0000, v12
    v_cndmask_b32 v17, v17, v3, vcc
    v_lshlrev_b32 v154, 16, v13
    v_and_b32 v155, 0xffff0000, v13
    v_lshlrev_b32 v156, 16, v14
    v_and_b32 v157, 0xffff0000, v14
    v_lshlrev_b32 v158, 16, v15
    v_and_b32 v159, 0xffff0000, v15
    s_and_b32 s51, s48, 15
    v_cmp_eq_u32 s[56:57], s51, v10
    s_cmp_ge_u32 s48, 16
    s_cselect_b64 s[58:59], s[56:57], 0
    s_cselect_b64 s[56:57], 0, s[56:57]
    s_mov_b32 s70, 0
    s_waitcnt vmcnt(0)
    s_branch L_poll_chk
L_poll:
    s_mov_b64 exec, vcc
    buffer_load_dwordx4 v[136:139], v1, s[32:35], s72 offen sc1
    buffer_load_dwordx4 v[140:143], v1, s[32:35], s72 offen offset:64 sc1
    buffer_load_dwordx4 v[144:147], v1, s[32:35], s72 offen offset:2048 sc1
    buffer_load_dwordx4 v[148:151], v1, s[32:35], s72 offen offset:2112 sc1
    s_mov_b64 exec, -1
    s_waitcnt vmcnt(0)
L_poll_chk:
    s_add_u32 s70, s70, 1
    v_cndmask_b32 v136, v136, v52, s[56:57]
    v_cndmask_b32 v144, v144, v52, s[58:59]
    v_cndmask_b32 v137, v137, v53, s[56:57]
    v_cndmask_b32 v145, v145, v53, s[58:59]
    v_cndmask_b32 v138, v138, v54, s[56:57]
    v_cndmask_b32 v146, v146, v54, s[58:59]
    v_cndmask_b32 v139, v139, v55, s[56:57]
    v_cndmask_b32 v147, v147, v55, s[58:59]
    v_cndmask_b32 v140, v140, v56, s[56:57]
    v_cndmask_b32 v148, v148, v56, s[58:59]
    v_cndmask_b32 v141, v141, v57, s[56:57]
    v_cndmask_b32 v149, v149, v57, s[58:59]
    v_cndmask_b32 v142, v142, v58, s[56:57]
    v_cndmask_b32 v150, v150, v58, s[58:59]
    v_cndmask_b32 v143, v143, v59, s[56:57]
    v_cndmask_b32 v151, v151, v59, s[58:59]
    v_and_b32 v3, v136, v137
    v_and_b32 v5, v138, v139
    v_and_b32 v3, v3, v5
    v_and_b32 v5, v140, v141
    v_and_b32 v3, v3, v5
    v_and_b32 v5, v142, v143
    v_and_b32 v3, v3, v5
    v_and_b32 v5, v144, v145
    v_and_b32 v3, v3, v5
    v_and_b32 v5, v146, v147
    v_and_b32 v3, v3, v5
    v_and_b32 v5, v148, v149
    v_and_b32 v3, v3, v5
    v_and_b32 v5, v150, v151
    v_and_b32 v3, v3, v5
    v_and_b32 v3, 1, v3
    v_cmp_eq_u32 vcc, 0, v3
    s_cmp_ge_u32 s70, 0x200000
    s_cbranch_scc1 L_poll_done
    s_cbranch_vccnz L_poll
L_poll_done:
    s_mov_b32 s52, 0x437f0000
    s_mov_b32 s53, 0x39035177
    v_mul_f32 v52, s52, v136
    v_mul_f32 v53, s52, v137
    v_mul_f32 v54, s52, v138
    v_mul_f32 v55, s52, v139
    v_fmac_f32 v52, v17, v144
    v_fmac_f32 v53, v17, v145
    v_fmac_f32 v54, v17, v146
    v_fmac_f32 v55, v17, v147
    v_add_f32 v56, v140, v148
    v_add_f32 v57, v141, v149
    v_add_f32 v58, v142, v150
    v_add_f32 v59, v143, v151
    v_add_f32_dpp v52, v52, v52 row_ror:8 row_mask:0xf bank_mask:0xf
    v_add_f32_dpp v53, v53, v53 row_ror:8 row_mask:0xf bank_mask:0xf
    v_add_f32_dpp v54, v54, v54 row_ror:8 row_mask:0xf bank_mask:0xf
    v_add_f32_dpp v55, v55, v55 row_ror:8 row_mask:0xf bank_mask:0xf
    v_add_f32_dpp v52, v52, v52 row_ror:4 row_mask:0xf bank_mask:0xf
    v_add_f32_dpp v53, v53, v53 row_ror:4 row_mask:0xf bank_mask:0xf
    v_add_f32_dpp v54, v54, v54 row_ror:4 row_mask:0xf bank_mask:0xf
    v_add_f32_dpp v55, v55, v55 row_ror:4 row_mask:0xf bank_mask:0xf
    v_add_f32_dpp v52, v52, v52 row_ror:2 row_mask:0xf bank_mask:0xf
    v_add_f32_dpp v53, v53, v53 row_ror:2 row_mask:0xf bank_mask:0xf
    v_add_f32_dpp v54, v54, v54 row_ror:2 row_mask:0xf bank_mask:0xf
    v_add_f32_dpp v55, v55, v55 row_ror:2 row_mask:0xf bank_mask:0xf
    v_add_f32_dpp v52, v52, v52 row_ror:1 row_mask:0xf bank_mask:0xf
    v_add_f32_dpp v53, v53, v53 row_ror:1 row_mask:0xf bank_mask:0xf
    v_add_f32_dpp v54, v54, v54 row_ror:1 row_mask:0xf bank_mask:0xf
    v_add_f32_dpp v55, v55, v55 row_ror:1 row_mask:0xf bank_mask:0xf
    v_mul_f32 v52, s53, v52
    v_mul_f32 v53, s53, v53
    v_mul_f32 v54, s53, v54
    v_mul_f32 v55, s53, v55
    v_sub_f32 v64, v136, v52
    v_sub_f32 v68, v144, v52
    v_sub_f32 v65, v137, v53
    v_sub_f32 v69, v145, v53
    v_sub_f32 v66, v138, v54
    v_sub_f32 v70, v146, v54
    v_sub_f32 v67, v139, v55
    v_sub_f32 v71, v147, v55
    v_mul_f32 v64, v64, v64
    v_mul_f32 v68, v68, v68
    v_mul_f32 v65, v65, v65
    v_mul_f32 v69, v69, v69
    v_mul_f32 v66, v66, v66
    v_mul_f32 v70, v70, v70
    v_mul_f32 v67, v67, v67
    v_mul_f32 v71, v71, v71
    v_fmac_f32 v56, s52, v64
    v_fmac_f32 v57, s52, v65
    v_fmac_f32 v58, s52, v66
    v_fmac_f32 v59, s52, v67
    v_fmac_f32 v56, v17, v68
    v_fmac_f32 v57, v17, v69
    v_fmac_f32 v58, v17, v70
    v_fmac_f32 v59, v17, v71
    s_nop 0
    v_add_f32_dpp v56, v56, v56 row_ror:8 row_mask:0xf bank_mask:0xf
    v_add_f32_dpp v57, v57, v57 row_ror:8 row_mask:0xf bank_mask:0xf
    v_add_f32_dpp v58, v58, v58 row_ror:8 row_mask:0xf bank_mask:0xf
    v_add_f32_dpp v59, v59, v59 row_ror:8 row_mask:0xf bank_mask:0xf
    v_add_f32_dpp v56, v56, v56 row_ror:4 row_mask:0xf bank_mask:0xf
    v_add_f32_dpp v57, v57, v57 row_ror:4 row_mask:0xf bank_mask:0xf
    v_add_f32_dpp v58, v58, v58 row_ror:4 row_mask:0xf bank_mask:0xf
    v_add_f32_dpp v59, v59, v59 row_ror:4 row_mask:0xf bank_mask:0xf
    v_add_f32_dpp v56, v56, v56 row_ror:2 row_mask:0xf bank_mask:0xf
    v_add_f32_dpp v57, v57, v57 row_ror:2 row_mask:0xf bank_mask:0xf
    v_add_f32_dpp v58, v58, v58 row_ror:2 row_mask:0xf bank_mask:0xf
    v_add_f32_dpp v59, v59, v59 row_ror:2 row_mask:0xf bank_mask:0xf
    v_add_f32_dpp v56, v56, v56 row_ror:1 row_mask:0xf bank_mask:0xf
    v_add_f32_dpp v57, v57, v57 row_ror:1 row_mask:0xf bank_mask:0xf
    v_add_f32_dpp v58, v58, v58 row_ror:1 row_mask:0xf bank_mask:0xf
    v_add_f32_dpp v59, v59, v59 row_ror:1 row_mask:0xf bank_mask:0xf
    v_mov_b32 v3, 0x3727c5ac
    v_fma_f32 v56, v56, s53, v3
    v_fma_f32 v57, v57, s53, v3
    v_fma_f32 v58, v58, s53, v3
    v_fma_f32 v59, v59, s53, v3
    v_rsq_f32 v56, v56
    v_rsq_f32 v57, v57
    v_rsq_f32 v58, v58
    v_rsq_f32 v59, v59
    s_nop 0
    v_mul_f32 v160, v56, v152
    v_mul_f32 v161, v57, v153
    v_mul_f32 v162, v58, v154
    v_mul_f32 v163, v59, v155
    v_fma_f32 v164, -v52, v160, v156
    v_fma_f32 v165, -v53, v161, v157
    v_fma_f32 v166, -v54, v162, v158
    v_fma_f32 v167, -v55, v163, v159
    s_lshl_b32 s51, s44, 6
    s_add_u32 s51, s51, 40960
    v_add_u32 v5, s51, v16
    v_cmp_eq_u32 vcc, 0, v10
    v_mov_b32 v3, 0x5a5a1234
    s_mov_b64 exec, vcc
    ds_write_b128 v5, v[160:163]
    ds_write_b128 v5, v[164:167] offset:256
    ds_write_b32 v9, v3
    s_mov_b64 exec, -1
L_final:
    s_mov_b32 s70, 0
L_mbox:
    ds_read_b128 v[116:119], v6
    s_add_u32 s70, s70, 1
    s_waitcnt lgkmcnt(0)
    v_and_b32 v116, v116, v117
    v_and_b32 v118, v118, v119
    v_and_b32 v116, v116, v118
    s_cmp_ge_u32 s70, 0x4000000
    v_readfirstlane_b32 s51, v116
    s_cbranch_scc1 L_mbox_d
    s_cmp_lg_u32 s51, 0x5a5a1234
    s_cbranch_scc1 L_mbox
L_mbox_d:
    ds_read_b128 v[136:139], v2 offset:0
    ds_read_b128 v[144:147], v2 offset:256
    ds_read_b128 v[140:143], v2 offset:16
    ds_read_b128 v[148:151], v2 offset:272
    s_waitcnt lgkmcnt(0)
    v_add_u32 v3, 0, v7
    v_cmp_gt_u32 vcc, s68, v3
    v_pk_fma_f32 v[84:85], v[84:85], v[136:137], v[144:145]
    v_pk_fma_f32 v[86:87], v[86:87], v[138:139], v[146:147]
    v_pk_fma_f32 v[88:89], v[88:89], v[140:141], v[148:149]
    v_pk_fma_f32 v[90:91], v[90:91], v[142:143], v[150:151]
    v_pk_mul_f32 v[116:117], v[84:85], v[84:85]
    v_pk_mul_f32 v[118:119], v[86:87], v[86:87]
    v_pk_mul_f32 v[120:121], v[88:89], v[88:89]
    v_pk_mul_f32 v[122:123], v[90:91], v[90:91]
    v_pk_fma_f32 v[116:117], v[116:117], v[170:171], v[168:169]
    v_pk_fma_f32 v[118:119], v[118:119], v[170:171], v[168:169]
    v_pk_fma_f32 v[120:121], v[120:121], v[170:171], v[168:169]
    v_pk_fma_f32 v[122:123], v[122:123], v[170:171], v[168:169]
    v_pk_mul_f32 v[116:117], v[116:117], v[84:85]
    v_pk_mul_f32 v[118:119], v[118:119], v[86:87]
    v_pk_mul_f32 v[120:121], v[120:121], v[88:89]
    v_pk_mul_f32 v[122:123], v[122:123], v[90:91]
    v_exp_f32 v116, v116
    v_exp_f32 v117, v117
    v_exp_f32 v118, v118
    v_exp_f32 v119, v119
    v_exp_f32 v120, v120
    v_exp_f32 v121, v121
    v_exp_f32 v122, v122
    v_exp_f32 v123, v123
    v_pk_add_f32 v[116:117], v[116:117], v[172:173]
    v_pk_add_f32 v[118:119], v[118:119], v[172:173]
    v_pk_add_f32 v[120:121], v[120:121], v[172:173]
    v_pk_add_f32 v[122:123], v[122:123], v[172:173]
    v_rcp_f32 v116, v116
    v_rcp_f32 v117, v117
    v_rcp_f32 v118, v118
    v_rcp_f32 v119, v119
    v_rcp_f32 v120, v120
    v_rcp_f32 v121, v121
    v_rcp_f32 v122, v122
    v_rcp_f32 v123, v123
    v_pk_mul_f32 v[84:85], v[84:85], v[116:117]
    v_pk_mul_f32 v[86:87], v[86:87], v[118:119]
    v_pk_mul_f32 v[88:89], v[88:89], v[120:121]
    v_pk_mul_f32 v[90:91], v[90:91], v[122:123]
    v_cvt_pk_bf16_f32 v20, v84, v85
    v_cvt_pk_bf16_f32 v21, v86, v87
    v_cvt_pk_bf16_f32 v22, v88, v89
    v_cvt_pk_bf16_f32 v23, v90, v91
    s_add_u32 s51, s69, 0
    s_mov_b64 exec, vcc
    buffer_store_dwordx4 v[20:23], v4, s[28:31], s51 offen sc1
    s_mov_b64 exec, -1
    v_add_u32 v3, 8, v7
    v_cmp_gt_u32 vcc, s68, v3
    v_pk_fma_f32 v[92:93], v[92:93], v[136:137], v[144:145]
    v_pk_fma_f32 v[94:95], v[94:95], v[138:139], v[146:147]
    v_pk_fma_f32 v[96:97], v[96:97], v[140:141], v[148:149]
    v_pk_fma_f32 v[98:99], v[98:99], v[142:143], v[150:151]
    v_pk_mul_f32 v[124:125], v[92:93], v[92:93]
    v_pk_mul_f32 v[126:127], v[94:95], v[94:95]
    v_pk_mul_f32 v[128:129], v[96:97], v[96:97]
    v_pk_mul_f32 v[130:131], v[98:99], v[98:99]
    v_pk_fma_f32 v[124:125], v[124:125], v[170:171], v[168:169]
    v_pk_fma_f32 v[126:127], v[126:127], v[170:171], v[168:169]
    v_pk_fma_f32 v[128:129], v[128:129], v[170:171], v[168:169]
    v_pk_fma_f32 v[130:131], v[130:131], v[170:171], v[168:169]
    v_pk_mul_f32 v[124:125], v[124:125], v[92:93]
    v_pk_mul_f32 v[126:127], v[126:127], v[94:95]
    v_pk_mul_f32 v[128:129], v[128:129], v[96:97]
    v_pk_mul_f32 v[130:131], v[130:131], v[98:99]
    v_exp_f32 v124, v124
    v_exp_f32 v125, v125
    v_exp_f32 v126, v126
    v_exp_f32 v127, v127
    v_exp_f32 v128, v128
    v_exp_f32 v129, v129
    v_exp_f32 v130, v130
    v_exp_f32 v131, v131
    v_pk_add_f32 v[124:125], v[124:125], v[172:173]
    v_pk_add_f32 v[126:127], v[126:127], v[172:173]
    v_pk_add_f32 v[128:129], v[128:129], v[172:173]
    v_pk_add_f32 v[130:131], v[130:131], v[172:173]
    v_rcp_f32 v124, v124
    v_rcp_f32 v125, v125
    v_rcp_f32 v126, v126
    v_rcp_f32 v127, v127
    v_rcp_f32 v128, v128
    v_rcp_f32 v129, v129
    v_rcp_f32 v130, v130
    v_rcp_f32 v131, v131
    v_pk_mul_f32 v[92:93], v[92:93], v[124:125]
    v_pk_mul_f32 v[94:95], v[94:95], v[126:127]
    v_pk_mul_f32 v[96:97], v[96:97], v[128:129]
    v_pk_mul_f32 v[98:99], v[98:99], v[130:131]
    v_cvt_pk_bf16_f32 v24, v92, v93
    v_cvt_pk_bf16_f32 v25, v94, v95
    v_cvt_pk_bf16_f32 v26, v96, v97
    v_cvt_pk_bf16_f32 v27, v98, v99
    s_add_u32 s51, s69, 4096
    s_mov_b64 exec, vcc
    buffer_store_dwordx4 v[24:27], v4, s[28:31], s51 offen sc1
    s_mov_b64 exec, -1
    v_add_u32 v3, 16, v7
    v_cmp_gt_u32 vcc, s68, v3
    v_pk_fma_f32 v[100:101], v[100:101], v[136:137], v[144:145]
    v_pk_fma_f32 v[102:103], v[102:103], v[138:139], v[146:147]
    v_pk_fma_f32 v[104:105], v[104:105], v[140:141], v[148:149]
    v_pk_fma_f32 v[106:107], v[106:107], v[142:143], v[150:151]
    v_pk_mul_f32 v[116:117], v[100:101], v[100:101]
    v_pk_mul_f32 v[118:119], v[102:103], v[102:103]
    v_pk_mul_f32 v[120:121], v[104:105], v[104:105]
    v_pk_mul_f32 v[122:123], v[106:107], v[106:107]
    v_pk_fma_f32 v[116:117], v[116:117], v[170:171], v[168:169]
    v_pk_fma_f32 v[118:119], v[118:119], v[170:171], v[168:169]
    v_pk_fma_f32 v[120:121], v[120:121], v[170:171], v[168:169]
    v_pk_fma_f32 v[122:123], v[122:123], v[170:171], v[168:169]
    v_pk_mul_f32 v[116:117], v[116:117], v[100:101]
    v_pk_mul_f32 v[118:119], v[118:119], v[102:103]
    v_pk_mul_f32 v[120:121], v[120:121], v[104:105]
    v_pk_mul_f32 v[122:123], v[122:123], v[106:107]
    v_exp_f32 v116, v116
    v_exp_f32 v117, v117
    v_exp_f32 v118, v118
    v_exp_f32 v119, v119
    v_exp_f32 v120, v120
    v_exp_f32 v121, v121
    v_exp_f32 v122, v122
    v_exp_f32 v123, v123
    v_pk_add_f32 v[116:117], v[116:117], v[172:173]
    v_pk_add_f32 v[118:119], v[118:119], v[172:173]
    v_pk_add_f32 v[120:121], v[120:121], v[172:173]
    v_pk_add_f32 v[122:123], v[122:123], v[172:173]
    v_rcp_f32 v116, v116
    v_rcp_f32 v117, v117
    v_rcp_f32 v118, v118
    v_rcp_f32 v119, v119
    v_rcp_f32 v120, v120
    v_rcp_f32 v121, v121
    v_rcp_f32 v122, v122
    v_rcp_f32 v123, v123
    v_pk_mul_f32 v[100:101], v[100:101], v[116:117]
    v_pk_mul_f32 v[102:103], v[102:103], v[118:119]
    v_pk_mul_f32 v[104:105], v[104:105], v[120:121]
    v_pk_mul_f32 v[106:107], v[106:107], v[122:123]
    v_cvt_pk_bf16_f32 v28, v100, v101
    v_cvt_pk_bf16_f32 v29, v102, v103
    v_cvt_pk_bf16_f32 v30, v104, v105
    v_cvt_pk_bf16_f32 v31, v106, v107
    s_add_u32 s51, s69, 8192
    s_mov_b64 exec, vcc
    buffer_store_dwordx4 v[28:31], v4, s[28:31], s51 offen sc1
    s_mov_b64 exec, -1
    v_add_u32 v3, 24, v7
    v_cmp_gt_u32 vcc, s68, v3
    v_pk_fma_f32 v[108:109], v[108:109], v[136:137], v[144:145]
    v_pk_fma_f32 v[110:111], v[110:111], v[138:139], v[146:147]
    v_pk_fma_f32 v[112:113], v[112:113], v[140:141], v[148:149]
    v_pk_fma_f32 v[114:115], v[114:115], v[142:143], v[150:151]
    v_pk_mul_f32 v[124:125], v[108:109], v[108:109]
    v_pk_mul_f32 v[126:127], v[110:111], v[110:111]
    v_pk_mul_f32 v[128:129], v[112:113], v[112:113]
    v_pk_mul_f32 v[130:131], v[114:115], v[114:115]
    v_pk_fma_f32 v[124:125], v[124:125], v[170:171], v[168:169]
    v_pk_fma_f32 v[126:127], v[126:127], v[170:171], v[168:169]
    v_pk_fma_f32 v[128:129], v[128:129], v[170:171], v[168:169]
    v_pk_fma_f32 v[130:131], v[130:131], v[170:171], v[168:169]
    v_pk_mul_f32 v[124:125], v[124:125], v[108:109]
    v_pk_mul_f32 v[126:127], v[126:127], v[110:111]
    v_pk_mul_f32 v[128:129], v[128:129], v[112:113]
    v_pk_mul_f32 v[130:131], v[130:131], v[114:115]
    v_exp_f32 v124, v124
    v_exp_f32 v125, v125
    v_exp_f32 v126, v126
    v_exp_f32 v127, v127
    v_exp_f32 v128, v128
    v_exp_f32 v129, v129
    v_exp_f32 v130, v130
    v_exp_f32 v131, v131
    v_pk_add_f32 v[124:125], v[124:125], v[172:173]
    v_pk_add_f32 v[126:127], v[126:127], v[172:173]
    v_pk_add_f32 v[128:129], v[128:129], v[172:173]
    v_pk_add_f32 v[130:131], v[130:131], v[172:173]
    v_rcp_f32 v124, v124
    v_rcp_f32 v125, v125
    v_rcp_f32 v126, v126
    v_rcp_f32 v127, v127
    v_rcp_f32 v128, v128
    v_rcp_f32 v129, v129
    v_rcp_f32 v130, v130
    v_rcp_f32 v131, v131
    v_pk_mul_f32 v[108:109], v[108:109], v[124:125]
    v_pk_mul_f32 v[110:111], v[110:111], v[126:127]
    v_pk_mul_f32 v[112:113], v[112:113], v[128:129]
    v_pk_mul_f32 v[114:115], v[114:115], v[130:131]
    v_cvt_pk_bf16_f32 v32, v108, v109
    v_cvt_pk_bf16_f32 v33, v110, v111
    v_cvt_pk_bf16_f32 v34, v112, v113
    v_cvt_pk_bf16_f32 v35, v114, v115
    s_add_u32 s51, s69, 12288
    s_mov_b64 exec, vcc
    buffer_store_dwordx4 v[32:35], v4, s[28:31], s51 offen sc1
    s_mov_b64 exec, -1
    s_endpgm
L_end:
    s_endpgm
.section .rodata,"a"
.p2align 6
.amdhsa_kernel standalone__self_sup_conv_stem_wavlm__speech_kernel
  .amdhsa_next_free_vgpr 200
  .amdhsa_next_free_sgpr 100
  .amdhsa_accum_offset 200
  .amdhsa_group_segment_fixed_size 0
  .amdhsa_kernarg_size 56
  .amdhsa_user_sgpr_count 2
  .amdhsa_user_sgpr_kernarg_segment_ptr 1
  .amdhsa_system_sgpr_workgroup_id_x 1
.end_amdhsa_kernel
```
